```python
import torch

def _softmax(x, axis=-1):
    return torch.softmax(x, dim=axis)
def _gelu(x):
    return torch.nn.functional.gelu(x, approximate="tanh")
def _silu(x):
    return torch.nn.functional.silu(x)
def _sigmoid(x):
    return torch.sigmoid(x)
def _layernorm(x, axis=-1, eps=1e-5):
    m = x.mean(dim=axis, keepdim=True)
    v = x.var(dim=axis, keepdim=True, unbiased=False)
    return (x - m) / torch.sqrt(v + eps)
def _scatter_add(tgt, idx, src, axis=0):
    return tgt.clone().index_add_(axis, idx, src)
def _segment_sum(src, seg, n):
    out = torch.zeros((n,) + src.shape[1:], dtype=src.dtype)
    return out.index_add_(0, seg, src)
def _pad(x, pw):
    flat = tuple(v for pair in reversed(pw) for v in pair)
    return torch.nn.functional.pad(x, flat)

kernel_name = 'interleave_layers__sliding_block_cached__dense_activation_mish__decode'

def setup_inputs():

    _w = (lambda a: (lambda t: t.to(torch.bfloat16) if t.is_floating_point() else t)(torch.as_tensor(a)))
    def _A_setup():
        B, Sq, D = 8, 1, 512
        Hq, Hkv, Sk, Dh = 32, 8, 4096, 128
        assert Hq % Hkv == 0, (Hq, Hkv)
        return {
            "x": _w((lambda *s: torch.randn(*s, dtype=torch.bfloat16) * 0.05)(B, Sq, D)),
            "k_cache": _w((lambda *s: torch.randn(*s, dtype=torch.bfloat16) * 0.8)(B, Hkv, Sk, Dh)),
            "v_cache": _w((lambda *s: torch.randn(*s, dtype=torch.bfloat16) * 1.6)(B, Hkv, Sk, Dh)),
            "wq": _w((lambda *s: torch.randn(*s, dtype=torch.bfloat16) * 0.8)(D, Hq * Dh) * (D ** -0.5)),
            "wo": _w((lambda *s: torch.randn(*s, dtype=torch.bfloat16) * 1.6)(Hq * Dh, D) * ((Hq * Dh) ** -0.5)),
        }
    _A_in = _A_setup()

    def _B_setup():
        B, S, D, F = 8, 1, 512, 1792
        return {
            "x": _w((lambda *s: torch.randn(*s, dtype=torch.bfloat16) * 0.05)(B, S, D)),
            "w1": _w((lambda *s: torch.randn(*s, dtype=torch.bfloat16) * 1.6)(D, F) * (D ** -0.5)),
            "b1": _w((lambda *s: torch.randn(*s, dtype=torch.bfloat16) * 0.4)(F)),
            "w2": _w((lambda *s: torch.randn(*s, dtype=torch.bfloat16) * 0.2)(F, D) * (F ** -0.5)),
        }
    _B_in = _B_setup()

    return {
        "A_x": _A_in["x"],
        "A_k_cache": _A_in["k_cache"],
        "A_v_cache": _A_in["v_cache"],
        "A_wq": _A_in["wq"],
        "A_wo": _A_in["wo"],
        "B_x": _B_in["x"],
        "B_w1": _B_in["w1"],
        "B_b1": _B_in["b1"],
        "B_w2": _B_in["w2"],
    }

def reference(A_x, A_k_cache, A_v_cache, A_wq, A_wo, B_x, B_w1, B_b1, B_w2):
    def _A_ref(x, k_cache, v_cache, wq, wo):
        B, Sq, D = x.shape
        Hq, Dh = 32, 128
        Hkv, Sk = k_cache.shape[1], k_cache.shape[2]
        W = min(4096, max(256, Sk // 4))
        rep = Hq // Hkv
        q = (lambda x, *d: x.permute(*d))((x @ wq).reshape(B, Sq, Hq, Dh), 0, 2, 1, 3)
        k = (lambda x, n, axis: torch.repeat_interleave(x, n, dim=axis))(k_cache[:, :, Sk - W:, :], rep, axis=1)
        v = (lambda x, n, axis: torch.repeat_interleave(x, n, dim=axis))(v_cache[:, :, Sk - W:, :], rep, axis=1)
        scores = torch.einsum("bhqd,bhkd->bhqk", q, k) * (Dh ** -0.5)
        p = _softmax(scores, axis=-1)
        o = torch.einsum("bhqk,bhkd->bhqd", p, v)
        return (lambda x, *d: x.permute(*d))(o, 0, 2, 1, 3).reshape(B, Sq, Hq * Dh) @ wo

    def _B_ref(x, w1, b1, w2):
        h = torch.einsum("bsd,df->bsf", x, w1) + b1
        sp = torch.log1p(torch.exp(-torch.abs(h))) + torch.where(h > 0, h, torch.zeros_like(h))
        act = h * torch.tanh(sp)
        return torch.einsum("bsf,fd->bsd", act, w2)

    x = A_x
    x = x + _A_ref(_layernorm(x, axis=-1), A_k_cache, A_v_cache, A_wq, A_wo)
    x = x + _B_ref(_layernorm(x, axis=-1), B_w1, B_b1, B_w2)
    x = x + _A_ref(_layernorm(x, axis=-1), A_k_cache, A_v_cache, A_wq, A_wo)
    x = x + _B_ref(_layernorm(x, axis=-1), B_w1, B_b1, B_w2)
    return x
```

```asm
; @launch grid=(256,1,1) block=(512,1,1) lds=159808
.amdgcn_target "amdgcn-amd-amdhsa--gfx950"
.text
.globl interleave_layers__sliding_block_cached__dense_activation_mish__decode_kernel
.p2align 8
.type interleave_layers__sliding_block_cached__dense_activation_mish__decode_kernel,@function
interleave_layers__sliding_block_cached__dense_activation_mish__decode_kernel:
    s_cmp_ge_u32 s2, 256
    s_cbranch_scc1 L_end
    s_load_dwordx16 s[4:19], s[0:1], 0
    s_load_dwordx8 s[20:27], s[0:1], 64
    v_lshrrev_b32 v24, 6, v0
    v_and_b32 v1, 63, v0
    v_readfirstlane_b32 s48, v24
    s_and_b32 s49, s2, 7
    s_lshr_b32 s50, s2, 3
    v_and_b32 v2, 15, v1
    v_lshrrev_b32 v3, 4, v1
    v_lshlrev_b32 v28, 2, v1
    v_add_u32 v28, 159744, v28
    v_cmp_eq_u32 vcc, 4, v1
    v_mov_b32 v29, 0
    v_mov_b32 v27, 35
    v_cndmask_b32 v29, v29, v27, vcc
    s_mov_b64 exec, 0xff
    ds_write_b32 v28, v29
    s_mov_b64 exec, -1
    v_lshrrev_b32 v24, 1, v1
    v_lshrrev_b32 v25, 4, v24
    v_bfe_u32 v26, v24, 2, 2
    v_lshlrev_b32 v26, 3, v26
    v_lshl_add_u32 v26, v25, 2, v26
    v_and_b32 v24, 3, v24
    v_add_u32 v26, v26, v24
    s_mov_b32 s61, 8192
    v_mul_lo_u32 v26, v26, s61
    v_and_b32 v24, 1, v1
    v_lshl_add_u32 v212, v24, 4, v26
    v_xor_b32 v24, v2, v3
    v_lshlrev_b32 v24, 4, v24
    v_lshl_add_u32 v196, v3, 8, v24
    s_lshl_b32 s57, s49, 10
    s_lshl_b32 s58, s50, 5
    s_add_u32 s57, s57, s58
    s_lshl_b32 s61, s48, 19
    s_lshl_b32 s62, s48, 11
    s_lshr_b32 s59, s50, 2
    s_lshl_b32 s59, s59, 3
    s_add_u32 s59, s59, s49
    s_lshl_b32 s59, s59, 20
    s_and_b32 s60, s50, 3
    s_lshl_b32 s60, s60, 16
    s_add_u32 s59, s59, s60
    s_add_u32 s77, s59, 786432
    s_sub_u32 s86, s48, 1
    s_max_i32 s86, s86, 0
    s_waitcnt lgkmcnt(0)
    s_barrier
    s_cmp_eq_u32 s48, 1
    s_cbranch_scc1 L_ctl
    s_add_u32 s32, s6, s77
    s_addc_u32 s33, s7, 0
    s_mov_b32 s34, 65536
    s_mov_b32 s35, 0x20000
    s_mov_b32 s88, s86
L_k0:
    s_mul_i32 s60, s2, 5
    s_add_u32 s60, s60, s88
    s_and_b32 s60, s60, 63
    s_and_b32 s59, s88, 64
    s_or_b32 s60, s60, s59
    s_lshl_b32 m0, s60, 10
    s_lshl_b32 s62, s60, 10
    s_and_b32 s61, s60, 3
    s_lshl_b32 s61, s61, 6
    v_xor_b32 v24, s61, v196
    buffer_load_dwordx4 v24, s[32:35], s62 offen nt lds
    s_add_u32 s88, s88, 7
    s_cmp_lt_u32 s88, 14
    s_cbranch_scc1 L_k0
    s_cmp_lt_u32 s88, 21
    s_cbranch_scc0 L_k0b
    s_lshl_b32 s61, s48, 19
    s_lshl_b32 s62, s48, 11
    s_add_u32 s36, s10, s57
    s_addc_u32 s37, s11, 0
    s_sub_u32 s38, 4194304, s57
    s_mov_b32 s39, 0x20000
    s_add_u32 m0, s62, 131072
    s_nop 0
    buffer_load_dwordx4 v212, s[36:39], s61 offen nt lds
    s_add_u32 s61, s61, 262144
    s_add_u32 m0, s62, 132096
    s_nop 0
    buffer_load_dwordx4 v212, s[36:39], s61 offen nt lds
L_k0b:
    s_cmp_lt_u32 s88, 35
    s_cbranch_scc1 L_k0
    s_mov_b32 s53, 0
    s_mov_b32 s3, 2000000
    v_lshlrev_b32 v9, 4, v1
    s_add_u32 s36, s8, s77
    s_addc_u32 s37, s9, 0
    s_mov_b32 s38, 65536
    s_mov_b32 s39, 0x20000
    s_getreg_b32 s82, hwreg(HW_REG_XCC_ID, 2, 1)
    s_cmp_eq_u32 s82, 1
    s_cselect_b32 s83, 4, 4
    s_cselect_b32 s89, 6, 6
    s_sub_u32 s80, s83, 1
    s_cmp_eq_u32 s48, 0
    s_cbranch_scc0 L_noinit
    s_mov_b32 s28, s26
    s_mov_b32 s29, s27
    s_mov_b32 s30, 4194304
    s_mov_b32 s31, 0x20000
    s_mov_b32 s40, s24
    s_mov_b32 s41, s25
    s_mov_b32 s42, 256
    s_mov_b32 s43, 0x20000
    v_lshlrev_b32 v9, 4, v1
    v_mov_b32 v204, -1
    v_mov_b32 v205, -1
    v_mov_b32 v206, -1
    v_mov_b32 v207, -1
    s_mul_i32 s59, s49, 163840
    s_mul_i32 s60, s50, 5120
    s_add_u32 s59, s59, s60
    s_add_u32 s60, s59, 4096
    s_mul_i32 s76, s2, 3072
    s_add_u32 s76, s76, 1310720
    buffer_store_dwordx4 v[204:207], v9, s[28:31], s59 offen offset:0
    buffer_store_dwordx4 v[204:207], v9, s[28:31], s59 offen offset:1024
    buffer_store_dwordx4 v[204:207], v9, s[28:31], s59 offen offset:2048
    buffer_store_dwordx4 v[204:207], v9, s[28:31], s59 offen offset:3072
    buffer_store_dwordx4 v[204:207], v9, s[28:31], s60 offen
    v_lshlrev_b32 v26, 3, v3
    v_lshl_add_u32 v26, v2, 10, v26
    s_lshl_b32 s59, s49, 13
    s_lshl_b32 s60, s50, 5
    s_add_u32 s59, s59, s60
    s_add_u32 s59, s59, 2097152
    v_cmp_gt_u32 vcc, 8, v2
    s_nop 0
    s_mov_b64 exec, vcc
    buffer_store_dwordx2 v[204:205], v26, s[28:31], s59 offen
    s_mov_b64 exec, -1
    buffer_store_dwordx4 v[204:207], v9, s[28:31], s76 offen offset:0 sc1
    buffer_store_dwordx4 v[204:207], v9, s[28:31], s76 offen offset:1024 sc1
    buffer_store_dwordx4 v[204:207], v9, s[28:31], s76 offen offset:2048 sc1
    s_getreg_b32 s84, hwreg(HW_REG_XCC_ID, 0, 4)
    s_or_b32 s85, s84, 0x30
    s_waitcnt vmcnt(0)
    s_lshl_b32 s61, s49, 5
    s_add_u32 s61, s61, s50
    v_mov_b32 v24, s85
    v_mov_b32 v25, 0
    s_mov_b64 exec, 1
    buffer_store_byte v24, v25, s[40:43], s61 offen
    s_mov_b64 exec, -1
    v_mov_b32 v28, 1
    v_mov_b32 v29, 159752
    ds_write_b32 v29, v28
    v_mov_b32 v28, 1
    v_mov_b32 v29, 159764
    s_mov_b64 exec, 1
    ds_add_u32 v29, v28
    s_mov_b64 exec, -1
    s_mov_b32 s80, 64
    s_waitcnt vmcnt(0)
    v_mov_b32 v28, 1
    v_mov_b32 v29, 159756
    ds_write_b32 v29, v28
L_noinit:
    v_lshrrev_b32 v24, 1, v2
    v_xor_b32 v24, v24, v3
    v_lshlrev_b32 v24, 5, v24
    v_and_b32 v25, 1, v2
    v_lshl_add_u32 v24, v25, 4, v24
    v_lshl_add_u32 v200, v3, 8, v24
    v_mov_b32 v208, 159760
    v_mov_b32 v209, 1
    v_mov_b32 v211, 0
    s_mov_b32 s87, 0
    s_mov_b64 exec, 1
    ds_add_rtn_u32 v210, v208, v209
    s_mov_b64 exec, -1
L_kvq:
    s_waitcnt lgkmcnt(0)
    v_readfirstlane_b32 s88, v210
    v_readfirstlane_b32 s81, v211
    s_cmp_lt_u32 s88, 128
    s_cbranch_scc0 L_kvdone
    s_mov_b64 exec, 1
    ds_add_rtn_u32 v210, v208, v209
    ds_read_b32 v211, v208 offset:8
    s_mov_b64 exec, -1
    s_mul_i32 s60, s2, 5
    s_add_u32 s60, s60, s88
    s_and_b32 s60, s60, 63
    s_and_b32 s59, s88, 64
    s_or_b32 s60, s60, s59
    s_lshl_b32 m0, s60, 10
    s_and_b32 s59, s60, 63
    s_lshl_b32 s59, s59, 10
    s_cmp_lt_u32 s88, 64
    s_cbranch_scc0 L_kvV
    s_and_b32 s61, s60, 3
    s_lshl_b32 s61, s61, 6
    v_xor_b32 v24, s61, v196
    s_waitcnt vmcnt(3)
    s_add_u32 s80, s80, 1
    s_cmp_eq_u32 s80, s83
    s_cbranch_scc0 Lsig_1
    v_mov_b32 v28, 1
    v_mov_b32 v29, 159764
    s_mov_b64 exec, 1
    ds_add_u32 v29, v28
    s_mov_b64 exec, -1
Lsig_1:
    buffer_load_dwordx4 v24, s[32:35], s59 offen nt lds
    s_mov_b32 s87, 0
    s_branch L_kvq
L_kvV:
    s_and_b32 s61, s60, 1
    s_lshl_b32 s61, s61, 7
    v_xor_b32 v24, s61, v200
    s_cmp_eq_u32 s81, 1
    s_cbranch_scc1 L_kvU
    s_waitcnt vmcnt(5)
    s_add_u32 s80, s80, 1
    s_cmp_eq_u32 s80, s83
    s_cbranch_scc0 Lsig_2
    v_mov_b32 v28, 1
    v_mov_b32 v29, 159764
    s_mov_b64 exec, 1
    ds_add_u32 v29, v28
    s_mov_b64 exec, -1
Lsig_2:
    s_add_u32 s87, s87, 1
L_kvU:
    buffer_load_dwordx4 v24, s[36:39], s59 offen nt lds
    s_branch L_kvq
L_kvdone:
    s_cmp_ge_u32 s87, s89
    s_cbranch_scc1 L_kvok
    s_waitcnt vmcnt(0)
L_kvok:
    s_mov_b32 s28, s26
    s_mov_b32 s29, s27
    s_mov_b32 s30, 4194304
    s_mov_b32 s31, 0x20000
    s_mov_b32 s40, s24
    s_mov_b32 s41, s25
    s_mov_b32 s42, 256
    s_mov_b32 s43, 0x20000
    v_lshlrev_b32 v9, 4, v1
    s_mov_b32 s44, s22
    s_mov_b32 s45, s23
    s_mov_b32 s46, 8192
    s_mov_b32 s47, 0x20000
    v_cmp_gt_u32 s[64:65], 8, v2
    v_cmp_gt_u32 s[68:69], 4, v2
    v_cmp_le_u32 s[70:71], 8, v2
    s_mov_b32 s66, -1
    s_mov_b32 s67, 0
    s_mov_b32 s14, 0xf0f0f0f0
    s_mov_b32 s15, 0xf0f0f0f0
    v_lshlrev_b32 v24, 7, v3
    v_lshl_add_u32 v4, v2, 4, v24
    s_lshr_b32 s57, s50, 2
    s_lshl_b32 s57, s57, 10
    s_and_b32 s58, s50, 1
    s_lshl_b32 s58, s58, 9
    s_add_u32 s57, s57, s58
    s_bfe_u32 s58, s50, 0x10001
    s_lshl_b32 s58, s58, 7
    s_add_u32 s57, s57, s58
    v_and_b32 v25, 7, v1
    v_bfe_u32 v26, v1, 3, 2
    v_lshrrev_b32 v27, 1, v26
    v_lshlrev_b32 v27, 8, v27
    v_lshl_add_u32 v27, v25, 4, v27
    v_and_b32 v6, 1, v26
    v_lshl_add_u32 v27, v6, 3, v27
    v_add_u32 v6, s57, v27
    s_lshl_b32 s58, s50, 5
    v_lshlrev_b32 v27, 3, v26
    v_lshl_add_u32 v27, v25, 10, v27
    v_add_u32 v5, s58, v27
    s_bfe_u32 s59, s50, 0x10002
    s_lshl_b32 s59, s59, 10
    s_lshr_b32 s60, s50, 3
    s_lshl_b32 s60, s60, 8
    s_add_u32 s59, s59, s60
    s_and_b32 s60, s50, 3
    s_lshl_b32 s60, s60, 2
    s_add_u32 s59, s59, s60
    v_add_u32 v7, s59, v9
    v_lshlrev_b32 v27, 3, v3
    v_lshl_add_u32 v8, v2, 10, v27
    v_add_u32 v8, s58, v8
    v_lshrrev_b32 v25, 1, v3
    v_and_b32 v26, 1, v3
    v_lshlrev_b32 v27, 8, v25
    v_lshl_add_u32 v27, v2, 4, v27
    v_lshl_add_u32 v27, v26, 3, v27
    v_add_u32 v13, s57, v27
    v_lshlrev_b32 v27, 8, v25
    v_lshl_add_u32 v27, v26, 3, v27
    v_lshl_add_u32 v27, v2, 13, v27
    s_bfe_u32 s59, s50, 0x10001
    s_lshl_b32 s59, s59, 12
    s_lshl_b32 s60, s48, 9
    s_add_u32 s59, s59, s60
    s_and_b32 s60, s50, 1
    s_lshl_b32 s60, s60, 7
    s_add_u32 s59, s59, s60
    s_lshr_b32 s60, s50, 2
    s_lshl_b32 s60, s60, 4
    s_add_u32 s59, s59, s60
    v_add_u32 v10, s59, v27
    s_lshr_b32 s59, s50, 4
    s_lshl_b32 s59, s59, 1
    s_lshr_b32 s60, s48, 2
    s_add_u32 s59, s59, s60
    s_lshl_b32 s60, s59, 8
    v_and_b32 v25, 7, v2
    v_lshlrev_b32 v27, 4, v25
    v_add_u32 v11, s60, v27
    s_lshl_b32 s59, s59, 1
    s_bfe_u32 s60, s48, 0x10001
    s_add_u32 s59, s59, s60
    s_lshl_b32 s59, s59, 2
    s_and_b32 s60, s48, 1
    s_lshl_b32 s60, s60, 1
    s_add_u32 s59, s59, s60
    s_lshl_b32 s78, s59, 10
    v_lshrrev_b32 v26, 3, v2
    v_lshl_add_u32 v27, v26, 13, v27
    v_add_u32 v27, v27, v24
    s_and_b32 s59, s50, 15
    s_lshl_b32 s59, s59, 14
    s_lshr_b32 s60, s50, 4
    s_lshl_b32 s61, s49, 1
    s_add_u32 s60, s60, s61
    s_lshl_b32 s60, s60, 9
    s_add_u32 s59, s59, s60
    v_add_u32 v12, s59, v27
    s_lshl_b32 s59, s50, 3
    s_add_u32 s59, s59, s49
    s_lshl_b32 s59, s59, 9
    v_add_u32 v14, s59, v4
    v_lshlrev_b32 v24, 4, v3
    v_and_b32 v25, 3, v2
    v_mul_u32_u24 v26, 320, v25
    v_add_u32 v26, v26, v24
    v_add_u32 v17, 147456, v26
    v_lshlrev_b32 v26, 6, v3
    v_lshl_add_u32 v26, v25, 4, v26
    v_add_u32 v20, 149504, v26
    v_lshlrev_b32 v26, 5, v25
    v_add_u32 v22, 148736, v26
    v_lshrrev_b32 v26, 2, v2
    v_lshl_add_u32 v27, v3, 2, v26
    v_and_b32 v26, 7, v27
    v_xor_b32 v26, s48, v26
    v_lshlrev_b32 v26, 5, v26
    v_lshl_add_u32 v26, v27, 8, v26
    v_lshl_add_u32 v26, v25, 3, v26
    v_add_u32 v18, 65536, v26
    v_lshlrev_b32 v26, 5, v27
    v_lshl_add_u32 v19, v25, 3, v26
    v_xor_b32 v26, v3, v25
    v_and_b32 v27, 12, v2
    v_or_b32 v26, v26, v27
    v_lshlrev_b32 v26, 4, v26
    v_lshl_add_u32 v26, v2, 8, v26
    s_lshl_b32 s59, s48, 13
    v_add_u32 v21, s59, v26
    v_and_b32 v26, 31, v1
    v_lshlrev_b32 v26, 4, v26
    v_add_u32 v23, 148992, v26
    s_mul_i32 s54, s49, 163840
    s_add_u32 s63, s54, 66560
    s_mov_b32 s55, 1310720
    s_mov_b32 s56, 1835008
    s_lshl_b32 s79, s49, 13
    s_add_u32 s79, s79, 2097152
    v_lshrrev_b32 v24, 4, v1
    v_bfe_u32 v25, v1, 2, 2
    v_lshl_add_u32 v25, v24, 3, v25
    v_lshlrev_b32 v25, 10, v25
    v_bfe_u32 v26, v1, 1, 1
    v_and_b32 v24, 1, v24
    v_xor_b32 v26, v26, v24
    v_lshl_add_u32 v25, v26, 5, v25
    v_and_b32 v26, 1, v1
    v_lshl_add_u32 v202, v26, 4, v25
    s_lshl_b32 s57, s49, 19
    s_lshr_b32 s58, s50, 4
    s_lshl_b32 s58, s58, 18
    s_add_u32 s57, s57, s58
    s_and_b32 s58, s50, 15
    s_lshl_b32 s58, s58, 6
    s_add_u32 s57, s57, s58
    s_add_u32 s32, s12, s57
    s_addc_u32 s33, s13, 0
    s_sub_u32 s34, 4194304, s57
    s_mov_b32 s35, 0x20000
    v_mov_b32 v29, 159748
    s_mov_b32 s52, 2000000
L_wqf:
    ds_read_b32 v28, v29
    s_waitcnt lgkmcnt(0)
    v_readfirstlane_b32 s58, v28
    s_nop 0
    s_cmp_eq_u32 s58, 1
    s_cbranch_scc1 L_wqf_d
    s_sub_u32 s52, s52, 1
    s_cbranch_scc0 L_wqf
L_wqf_d:
    s_mov_b32 s88, s86
L_wol:
    s_lshr_b32 s59, s88, 1
    s_lshl_b32 s59, s59, 15
    s_and_b32 s60, s88, 1
    s_lshl_b32 s60, s60, 12
    s_add_u32 s59, s59, s60
    s_lshl_b32 s60, s88, 10
    s_add_u32 m0, s60, 131072
    s_nop 0
    buffer_load_dwordx4 v202, s[32:35], s59 offen nt lds
    s_add_u32 s88, s88, 7
    s_cmp_lt_u32 s88, 16
    s_cbranch_scc1 L_wol
    s_branch L_barA
L_ctl:
    s_lshl_b32 s61, s48, 19
    s_lshl_b32 s62, s48, 11
    s_add_u32 s36, s10, s57
    s_addc_u32 s37, s11, 0
    s_sub_u32 s38, 4194304, s57
    s_mov_b32 s39, 0x20000
    s_add_u32 m0, s62, 131072
    s_nop 0
    buffer_load_dwordx4 v212, s[36:39], s61 offen nt lds
    s_add_u32 s61, s61, 262144
    s_add_u32 m0, s62, 132096
    s_nop 0
    buffer_load_dwordx4 v212, s[36:39], s61 offen nt lds
    v_and_b32 v25, 7, v1
    v_lshlrev_b32 v201, 4, v3
    v_lshl_add_u32 v201, v25, 10, v201
    v_bfe_u32 v26, v1, 3, 1
    v_lshl_add_u32 v201, v26, 6, v201
    v_bfe_u32 v26, v1, 3, 2
    v_lshlrev_b32 v26, 3, v26
    v_lshl_add_u32 v202, v25, 10, v26
    s_mov_b32 s53, 0
    s_mov_b32 s3, 2000000
    v_lshlrev_b32 v9, 4, v1
    s_mov_b32 s36, s4
    s_mov_b32 s37, s5
    s_mov_b32 s38, 8192
    s_mov_b32 s39, 0x20000
    buffer_load_dwordx4 v[32:35], v201, s[36:39], 0 offen offset:0
    buffer_load_dwordx4 v[36:39], v201, s[36:39], 0 offen offset:128
    buffer_load_dwordx4 v[40:43], v201, s[36:39], 0 offen offset:256
    buffer_load_dwordx4 v[44:47], v201, s[36:39], 0 offen offset:384
    buffer_load_dwordx4 v[48:51], v201, s[36:39], 0 offen offset:512
    buffer_load_dwordx4 v[52:55], v201, s[36:39], 0 offen offset:640
    buffer_load_dwordx4 v[56:59], v201, s[36:39], 0 offen offset:768
    buffer_load_dwordx4 v[60:63], v201, s[36:39], 0 offen offset:896
    buffer_load_dwordx2 v[30:31], v202, s[36:39], s58 offen
    s_getpc_b64 s[32:33]
L_pcref:
    s_sub_u32 s32, s32, L_pcref-interleave_layers__sliding_block_cached__dense_activation_mish__decode_kernel
    s_subb_u32 s33, s33, 0
    s_mov_b32 s34, L_end-interleave_layers__sliding_block_cached__dense_activation_mish__decode_kernel
    s_mov_b32 s35, 0x20000
    s_and_b32 s59, s50, 15
    s_lshl_b32 s59, s59, 10
    buffer_load_dwordx4 v[160:163], v9, s[32:35], s59 offen
    s_mov_b32 s28, s26
    s_mov_b32 s29, s27
    s_mov_b32 s30, 4194304
    s_mov_b32 s31, 0x20000
    s_mov_b32 s40, s24
    s_mov_b32 s41, s25
    s_mov_b32 s42, 256
    s_mov_b32 s43, 0x20000
    v_lshlrev_b32 v9, 4, v1
    s_getreg_b32 s84, hwreg(HW_REG_XCC_ID, 0, 4)
    s_or_b32 s85, s84, 0x30
    s_mov_b32 s44, s22
    s_mov_b32 s45, s23
    s_mov_b32 s46, 8192
    s_mov_b32 s47, 0x20000
    v_cmp_gt_u32 s[64:65], 8, v2
    v_cmp_gt_u32 s[68:69], 4, v2
    v_cmp_le_u32 s[70:71], 8, v2
    s_mov_b32 s66, -1
    s_mov_b32 s67, 0
    s_mov_b32 s14, 0xf0f0f0f0
    s_mov_b32 s15, 0xf0f0f0f0
    v_lshlrev_b32 v24, 7, v3
    v_lshl_add_u32 v4, v2, 4, v24
    s_lshr_b32 s57, s50, 2
    s_lshl_b32 s57, s57, 10
    s_and_b32 s58, s50, 1
    s_lshl_b32 s58, s58, 9
    s_add_u32 s57, s57, s58
    s_bfe_u32 s58, s50, 0x10001
    s_lshl_b32 s58, s58, 7
    s_add_u32 s57, s57, s58
    v_and_b32 v25, 7, v1
    v_bfe_u32 v26, v1, 3, 2
    v_lshrrev_b32 v27, 1, v26
    v_lshlrev_b32 v27, 8, v27
    v_lshl_add_u32 v27, v25, 4, v27
    v_and_b32 v6, 1, v26
    v_lshl_add_u32 v27, v6, 3, v27
    v_add_u32 v6, s57, v27
    s_lshl_b32 s58, s50, 5
    v_lshlrev_b32 v27, 3, v26
    v_lshl_add_u32 v27, v25, 10, v27
    v_add_u32 v5, s58, v27
    s_bfe_u32 s59, s50, 0x10002
    s_lshl_b32 s59, s59, 10
    s_lshr_b32 s60, s50, 3
    s_lshl_b32 s60, s60, 8
    s_add_u32 s59, s59, s60
    s_and_b32 s60, s50, 3
    s_lshl_b32 s60, s60, 2
    s_add_u32 s59, s59, s60
    v_add_u32 v7, s59, v9
    v_lshlrev_b32 v27, 3, v3
    v_lshl_add_u32 v8, v2, 10, v27
    v_add_u32 v8, s58, v8
    v_lshrrev_b32 v25, 1, v3
    v_and_b32 v26, 1, v3
    v_lshlrev_b32 v27, 8, v25
    v_lshl_add_u32 v27, v2, 4, v27
    v_lshl_add_u32 v27, v26, 3, v27
    v_add_u32 v13, s57, v27
    v_lshlrev_b32 v27, 8, v25
    v_lshl_add_u32 v27, v26, 3, v27
    v_lshl_add_u32 v27, v2, 13, v27
    s_bfe_u32 s59, s50, 0x10001
    s_lshl_b32 s59, s59, 12
    s_lshl_b32 s60, s48, 9
    s_add_u32 s59, s59, s60
    s_and_b32 s60, s50, 1
    s_lshl_b32 s60, s60, 7
    s_add_u32 s59, s59, s60
    s_lshr_b32 s60, s50, 2
    s_lshl_b32 s60, s60, 4
    s_add_u32 s59, s59, s60
    v_add_u32 v10, s59, v27
    s_lshr_b32 s59, s50, 4
    s_lshl_b32 s59, s59, 1
    s_lshr_b32 s60, s48, 2
    s_add_u32 s59, s59, s60
    s_lshl_b32 s60, s59, 8
    v_and_b32 v25, 7, v2
    v_lshlrev_b32 v27, 4, v25
    v_add_u32 v11, s60, v27
    s_lshl_b32 s59, s59, 1
    s_bfe_u32 s60, s48, 0x10001
    s_add_u32 s59, s59, s60
    s_lshl_b32 s59, s59, 2
    s_and_b32 s60, s48, 1
    s_lshl_b32 s60, s60, 1
    s_add_u32 s59, s59, s60
    s_lshl_b32 s78, s59, 10
    v_lshrrev_b32 v26, 3, v2
    v_lshl_add_u32 v27, v26, 13, v27
    v_add_u32 v27, v27, v24
    s_and_b32 s59, s50, 15
    s_lshl_b32 s59, s59, 14
    s_lshr_b32 s60, s50, 4
    s_lshl_b32 s61, s49, 1
    s_add_u32 s60, s60, s61
    s_lshl_b32 s60, s60, 9
    s_add_u32 s59, s59, s60
    v_add_u32 v12, s59, v27
    s_lshl_b32 s59, s50, 3
    s_add_u32 s59, s59, s49
    s_lshl_b32 s59, s59, 9
    v_add_u32 v14, s59, v4
    v_lshlrev_b32 v24, 4, v3
    v_and_b32 v25, 3, v2
    v_mul_u32_u24 v26, 320, v25
    v_add_u32 v26, v26, v24
    v_add_u32 v17, 147456, v26
    v_lshlrev_b32 v26, 6, v3
    v_lshl_add_u32 v26, v25, 4, v26
    v_add_u32 v20, 149504, v26
    v_lshlrev_b32 v26, 5, v25
    v_add_u32 v22, 148736, v26
    v_lshrrev_b32 v26, 2, v2
    v_lshl_add_u32 v27, v3, 2, v26
    v_and_b32 v26, 7, v27
    v_xor_b32 v26, s48, v26
    v_lshlrev_b32 v26, 5, v26
    v_lshl_add_u32 v26, v27, 8, v26
    v_lshl_add_u32 v26, v25, 3, v26
    v_add_u32 v18, 65536, v26
    v_lshlrev_b32 v26, 5, v27
    v_lshl_add_u32 v19, v25, 3, v26
    v_xor_b32 v26, v3, v25
    v_and_b32 v27, 12, v2
    v_or_b32 v26, v26, v27
    v_lshlrev_b32 v26, 4, v26
    v_lshl_add_u32 v26, v2, 8, v26
    s_lshl_b32 s59, s48, 13
    v_add_u32 v21, s59, v26
    v_and_b32 v26, 31, v1
    v_lshlrev_b32 v26, 4, v26
    v_add_u32 v23, 148992, v26
    s_mul_i32 s54, s49, 163840
    s_add_u32 s63, s54, 66560
    s_mov_b32 s55, 1310720
    s_mov_b32 s56, 1835008
    s_lshl_b32 s79, s49, 13
    s_add_u32 s79, s79, 2097152
    s_waitcnt vmcnt(0)
    v_mov_b32 v29, 159764
    s_mov_b32 s52, 2000000
L_w20:
    ds_read_b32 v28, v29
    s_waitcnt lgkmcnt(0)
    v_readfirstlane_b32 s58, v28
    s_nop 0
    s_cmp_eq_u32 s58, 7
    s_cbranch_scc1 L_w20_d
    s_sub_u32 s52, s52, 1
    s_cbranch_scc0 L_w20
L_w20_d:
    v_add_u32 v24, 131072, v19
    ds_read_b64_tr_b16 v[96:97], v24 offset:0
    ds_read_b64_tr_b16 v[98:99], v24 offset:512
    ds_read_b64_tr_b16 v[100:101], v24 offset:1024
    ds_read_b64_tr_b16 v[102:103], v24 offset:1536
    ds_read_b64_tr_b16 v[104:105], v24 offset:2048
    ds_read_b64_tr_b16 v[106:107], v24 offset:2560
    ds_read_b64_tr_b16 v[108:109], v24 offset:3072
    ds_read_b64_tr_b16 v[110:111], v24 offset:3584
    ds_read_b64_tr_b16 v[112:113], v24 offset:4096
    ds_read_b64_tr_b16 v[114:115], v24 offset:4608
    ds_read_b64_tr_b16 v[116:117], v24 offset:5120
    ds_read_b64_tr_b16 v[118:119], v24 offset:5632
    ds_read_b64_tr_b16 v[120:121], v24 offset:6144
    ds_read_b64_tr_b16 v[122:123], v24 offset:6656
    ds_read_b64_tr_b16 v[124:125], v24 offset:7168
    ds_read_b64_tr_b16 v[126:127], v24 offset:7680
    ds_read_b64_tr_b16 v[128:129], v24 offset:8192
    ds_read_b64_tr_b16 v[130:131], v24 offset:8704
    ds_read_b64_tr_b16 v[132:133], v24 offset:9216
    ds_read_b64_tr_b16 v[134:135], v24 offset:9728
    ds_read_b64_tr_b16 v[136:137], v24 offset:10240
    ds_read_b64_tr_b16 v[138:139], v24 offset:10752
    ds_read_b64_tr_b16 v[140:141], v24 offset:11264
    ds_read_b64_tr_b16 v[142:143], v24 offset:11776
    ds_read_b64_tr_b16 v[144:145], v24 offset:12288
    ds_read_b64_tr_b16 v[146:147], v24 offset:12800
    ds_read_b64_tr_b16 v[148:149], v24 offset:13312
    ds_read_b64_tr_b16 v[150:151], v24 offset:13824
    ds_read_b64_tr_b16 v[152:153], v24 offset:14336
    ds_read_b64_tr_b16 v[154:155], v24 offset:14848
    ds_read_b64_tr_b16 v[156:157], v24 offset:15360
    ds_read_b64_tr_b16 v[158:159], v24 offset:15872
    v_lshlrev_b32 v196, 16, v30
    v_and_b32 v197, 0xffff0000, v30
    v_lshlrev_b32 v198, 16, v31
    v_and_b32 v199, 0xffff0000, v31
    ds_write_b128 v23, v[196:199]
    v_mov_b32 v204, 0x3f803f80
    v_mov_b32 v205, 0x3f803f80
    v_mov_b32 v206, 0x3f803f80
    v_mov_b32 v207, 0x3f803f80
    s_waitcnt lgkmcnt(0)
    v_mov_b32 v28, 1
    v_mov_b32 v29, 159748
    ds_write_b32 v29, v28
    v_mfma_f32_16x16x32_bf16 v[216:219], v[96:99], v[32:35], 0
    v_mfma_f32_16x16x32_bf16 v[220:223], v[100:103], v[32:35], 0
    v_mfma_f32_16x16x32_bf16 v[188:191], v[96:99], v[204:207], 0
    v_mfma_f32_16x16x32_bf16 v[208:211], v[32:35], v[32:35], 0
    v_mfma_f32_16x16x32_bf16 v[188:191], v[100:103], v[204:207], v[188:191]
    v_mfma_f32_16x16x32_bf16 v[212:215], v[204:207], v[32:35], 0
    v_mfma_f32_16x16x32_bf16 v[216:219], v[104:107], v[36:39], v[216:219]
    v_mfma_f32_16x16x32_bf16 v[220:223], v[108:111], v[36:39], v[220:223]
    v_mfma_f32_16x16x32_bf16 v[188:191], v[104:107], v[204:207], v[188:191]
    v_mfma_f32_16x16x32_bf16 v[208:211], v[36:39], v[36:39], v[208:211]
    v_mfma_f32_16x16x32_bf16 v[188:191], v[108:111], v[204:207], v[188:191]
    v_mfma_f32_16x16x32_bf16 v[212:215], v[204:207], v[36:39], v[212:215]
    v_mfma_f32_16x16x32_bf16 v[216:219], v[112:115], v[40:43], v[216:219]
    v_mfma_f32_16x16x32_bf16 v[220:223], v[116:119], v[40:43], v[220:223]
    v_mfma_f32_16x16x32_bf16 v[188:191], v[112:115], v[204:207], v[188:191]
    v_mfma_f32_16x16x32_bf16 v[208:211], v[40:43], v[40:43], v[208:211]
    v_mfma_f32_16x16x32_bf16 v[188:191], v[116:119], v[204:207], v[188:191]
    v_mfma_f32_16x16x32_bf16 v[212:215], v[204:207], v[40:43], v[212:215]
    v_mfma_f32_16x16x32_bf16 v[216:219], v[120:123], v[44:47], v[216:219]
    v_mfma_f32_16x16x32_bf16 v[220:223], v[124:127], v[44:47], v[220:223]
    v_mfma_f32_16x16x32_bf16 v[188:191], v[120:123], v[204:207], v[188:191]
    v_mfma_f32_16x16x32_bf16 v[208:211], v[44:47], v[44:47], v[208:211]
    v_mfma_f32_16x16x32_bf16 v[188:191], v[124:127], v[204:207], v[188:191]
    v_mfma_f32_16x16x32_bf16 v[212:215], v[204:207], v[44:47], v[212:215]
    v_mfma_f32_16x16x32_bf16 v[216:219], v[128:131], v[48:51], v[216:219]
    v_mfma_f32_16x16x32_bf16 v[220:223], v[132:135], v[48:51], v[220:223]
    v_mfma_f32_16x16x32_bf16 v[188:191], v[128:131], v[204:207], v[188:191]
    v_mfma_f32_16x16x32_bf16 v[208:211], v[48:51], v[48:51], v[208:211]
    v_mfma_f32_16x16x32_bf16 v[188:191], v[132:135], v[204:207], v[188:191]
    v_mfma_f32_16x16x32_bf16 v[212:215], v[204:207], v[48:51], v[212:215]
    v_mfma_f32_16x16x32_bf16 v[216:219], v[136:139], v[52:55], v[216:219]
    v_mfma_f32_16x16x32_bf16 v[220:223], v[140:143], v[52:55], v[220:223]
    v_mfma_f32_16x16x32_bf16 v[188:191], v[136:139], v[204:207], v[188:191]
    v_mfma_f32_16x16x32_bf16 v[208:211], v[52:55], v[52:55], v[208:211]
    v_mfma_f32_16x16x32_bf16 v[188:191], v[140:143], v[204:207], v[188:191]
    v_mfma_f32_16x16x32_bf16 v[212:215], v[204:207], v[52:55], v[212:215]
    v_mfma_f32_16x16x32_bf16 v[216:219], v[144:147], v[56:59], v[216:219]
    v_mfma_f32_16x16x32_bf16 v[220:223], v[148:151], v[56:59], v[220:223]
    v_mfma_f32_16x16x32_bf16 v[188:191], v[144:147], v[204:207], v[188:191]
    v_mfma_f32_16x16x32_bf16 v[208:211], v[56:59], v[56:59], v[208:211]
    v_mfma_f32_16x16x32_bf16 v[188:191], v[148:151], v[204:207], v[188:191]
    v_mfma_f32_16x16x32_bf16 v[212:215], v[204:207], v[56:59], v[212:215]
    v_mfma_f32_16x16x32_bf16 v[216:219], v[152:155], v[60:63], v[216:219]
    v_mfma_f32_16x16x32_bf16 v[220:223], v[156:159], v[60:63], v[220:223]
    v_mfma_f32_16x16x32_bf16 v[188:191], v[152:155], v[204:207], v[188:191]
    v_mfma_f32_16x16x32_bf16 v[208:211], v[60:63], v[60:63], v[208:211]
    v_mfma_f32_16x16x32_bf16 v[188:191], v[156:159], v[204:207], v[188:191]
    v_mfma_f32_16x16x32_bf16 v[212:215], v[204:207], v[60:63], v[212:215]
    s_nop 3
    v_add_f32_dpp v216, v220, v216 row_ror:8 row_mask:0xf bank_mask:0xf
    v_add_f32_dpp v217, v221, v217 row_ror:8 row_mask:0xf bank_mask:0xf
    v_add_f32_dpp v218, v222, v218 row_ror:8 row_mask:0xf bank_mask:0xf
    v_add_f32_dpp v219, v223, v219 row_ror:8 row_mask:0xf bank_mask:0xf
    v_add_f32_dpp v212, v212, v212 row_ror:8 row_mask:0xf bank_mask:0xf
    v_and_b32 v24, 1, v2
    v_cmp_eq_u32 vcc, 1, v24
    s_nop 1
    v_cndmask_b32 v25, v208, v209, vcc
    v_cndmask_b32 v26, v210, v211, vcc
    v_and_b32 v24, 2, v2
    v_cmp_eq_u32 vcc, 2, v24
    s_nop 1
    v_cndmask_b32 v25, v25, v26, vcc
    v_lshrrev_b32 v24, 2, v2
    v_cmp_eq_u32 vcc, v24, v3
    v_mov_b32 v26, 0
    s_nop 0
    v_cndmask_b32 v26, v26, v25, vcc
    v_mov_b32 v25, v26
    s_nop 1
    v_permlane16_swap_b32 v26, v25
    v_add_f32 v26, v26, v25
    v_mov_b32 v25, v26
    s_nop 1
    v_permlane32_swap_b32 v26, v25
    v_add_f32 v26, v26, v25
    s_nop 1
    v_add_f32_dpp v26, v26, v26 row_ror:8 row_mask:0xf bank_mask:0xf
    v_mul_f32 v27, 0x3b000000, v212
    v_mul_f32 v26, 0x3b000000, v26
    v_fma_f32 v26, -v27, v27, v26
    v_max_f32 v26, 0, v26
    v_add_f32 v26, 0x3727c5ac, v26
    v_rsq_f32 v28, v26
    v_fma_f32 v216, -v27, v188, v216
    v_fma_f32 v217, -v27, v189, v217
    v_fma_f32 v218, -v27, v190, v218
    v_fma_f32 v219, -v27, v191, v219
    v_mul_f32 v216, v216, v28
    v_mul_f32 v217, v217, v28
    v_mul_f32 v218, v218, v28
    v_mul_f32 v219, v219, v28
    v_cvt_pk_bf16_f32 v196, v216, v217
    v_cvt_pk_bf16_f32 v197, v218, v219
    v_min_u32 v196, -2, v196
    v_min_u32 v197, -2, v197
    v_mov_b32 v29, 159752
    s_mov_b32 s52, 2000000
L_w8:
    ds_read_b32 v28, v29
    s_waitcnt lgkmcnt(0)
    v_readfirstlane_b32 s58, v28
    s_nop 0
    s_cmp_eq_u32 s58, 1
    s_cbranch_scc1 L_w8_d
    s_sub_u32 s52, s52, 1
    s_cbranch_scc0 L_w8
L_w8_d:
    s_mov_b64 exec, s[64:65]
    buffer_store_dwordx2 v[196:197], v8, s[28:31], s79 offen
    s_mov_b64 exec, -1
    s_lshr_b32 s60, s50, 2
    s_lshl_b32 s60, s60, 10
    s_add_u32 s76, s79, s60
    s_lshl_b32 s77, s49, 5
    s_mul_i32 s57, s84, 0x01010101
    s_mov_b32 s52, 2000000
L_q0:
    v_lshlrev_b32 v25, 2, v1
    s_mov_b64 exec, 0xff
    buffer_load_dword v26, v25, s[40:43], s77 offen sc1
    s_mov_b64 exec, -1
    buffer_load_dwordx4 v[204:207], v9, s[28:31], s76 offen sc1
    s_waitcnt vmcnt(0)
    v_and_b32 v27, 0x10101010, v26
    s_mov_b64 exec, 0xff
    v_cmp_ne_u32 vcc, 0x10101010, v27
    s_mov_b64 exec, -1
    s_cbranch_vccz L_q0_flags
    s_cmp_eq_u32 s52, 1999936
    s_cbranch_scc0 L_q0_next
    s_mov_b32 s59, s52
    v_mov_b32 v29, 159756
    s_mov_b32 s52, 2000000
L_w12a:
    ds_read_b32 v28, v29
    s_waitcnt lgkmcnt(0)
    v_readfirstlane_b32 s58, v28
    s_nop 0
    s_cmp_eq_u32 s58, 1
    s_cbranch_scc1 L_w12a_d
    s_sub_u32 s52, s52, 1
    s_cbranch_scc0 L_w12a
L_w12a_d:
    s_lshl_b32 s61, s49, 5
    s_add_u32 s61, s61, s50
    v_mov_b32 v24, s85
    v_mov_b32 v25, 0
    s_mov_b64 exec, 1
    buffer_store_byte v24, v25, s[40:43], s61 offen sc1
    s_mov_b64 exec, -1
    s_mov_b32 s52, s59
L_q0_next:
    s_sub_u32 s52, s52, 1
    s_cbranch_scc0 L_q0
    s_branch L_q0_slow
L_q0_flags:
    v_and_b32 v27, 0x0f0f0f0f, v26
    s_mov_b64 exec, 0xff
    v_cmp_ne_u32 vcc, s57, v27
    s_mov_b64 exec, -1
    s_cbranch_vccnz L_q0_slow
    v_max3_u32 v31, v204, v205, v206
    v_max_u32 v31, v31, v207
    v_cmp_eq_u32 vcc, -1, v31
    s_cbranch_vccnz L_q0_next
    s_mov_b32 s51, 1
    s_branch L_q0_done
L_q0_slow:
    s_mov_b32 s51, 0
    v_mov_b32 v29, 159756
    s_mov_b32 s52, 2000000
L_w12b:
    ds_read_b32 v28, v29
    s_waitcnt lgkmcnt(0)
    v_readfirstlane_b32 s58, v28
    s_nop 0
    s_cmp_eq_u32 s58, 1
    s_cbranch_scc1 L_w12b_d
    s_sub_u32 s52, s52, 1
    s_cbranch_scc0 L_w12b
L_w12b_d:
    v_mov_b32 v200, -1
    v_mov_b32 v201, -1
    v_mov_b32 v202, -1
    v_mov_b32 v203, -1
    s_mul_i32 s57, s49, 163840
    s_mul_i32 s58, s50, 5120
    s_add_u32 s57, s57, s58
    s_add_u32 s58, s57, 4096
    buffer_store_dwordx4 v[200:203], v9, s[28:31], s57 offen offset:0 sc1
    buffer_store_dwordx4 v[200:203], v9, s[28:31], s57 offen offset:1024 sc1
    buffer_store_dwordx4 v[200:203], v9, s[28:31], s57 offen offset:2048 sc1
    buffer_store_dwordx4 v[200:203], v9, s[28:31], s57 offen offset:3072 sc1
    buffer_store_dwordx4 v[200:203], v9, s[28:31], s58 offen sc1
    s_mov_b64 exec, s[64:65]
    buffer_store_dwordx2 v[200:201], v8, s[28:31], s79 offen sc1
    s_mov_b64 exec, -1
    s_waitcnt vmcnt(0)
    s_or_b32 s85, s85, 0x80
    s_lshl_b32 s61, s49, 5
    s_add_u32 s61, s61, s50
    v_mov_b32 v24, s85
    v_mov_b32 v25, 0
    s_mov_b64 exec, 1
    buffer_store_byte v24, v25, s[40:43], s61 offen sc1
    s_mov_b64 exec, -1
    s_mov_b32 s52, 2000000
    s_lshl_b32 s62, s49, 5
Lgp_3:
    v_lshlrev_b32 v25, 2, v1
    s_mov_b64 exec, 0xff
    buffer_load_dword v26, v25, s[40:43], s62 offen sc1
    s_waitcnt vmcnt(0)
    v_and_b32 v27, 0x80808080, v26
    v_cmp_ne_u32 vcc, 0x80808080, v27
    s_mov_b64 exec, -1
    s_cbranch_vccz Lgd_4
    s_sub_u32 s52, s52, 1
    s_cbranch_scc0 Lgp_3
Lgd_4:
    s_mov_b64 exec, s[64:65]
    buffer_store_dwordx2 v[196:197], v8, s[28:31], s79 offen sc1
    s_mov_b64 exec, -1
    s_mov_b32 s52, s3
Lpoll_6:
    buffer_load_dwordx4 v[204:207], v9, s[28:31], s76 offen sc1
    s_waitcnt vmcnt(0)
    v_max3_u32 v31, v204, v205, v206
    v_max_u32 v31, v31, v207
    v_cmp_eq_u32 vcc, -1, v31
    s_cbranch_vccz Lpd_7
    s_sub_u32 s52, s52, 1
    s_cbranch_scc0 Lpoll_6
    s_mov_b32 s3, 0
Lpd_7:
L_q0_done:
    v_mov_b32 v28, 1
    v_mov_b32 v29, 159768
    ds_write_b32 v29, v28
    v_mov_b32 v24, s51
    v_mov_b32 v25, 159744
    ds_write_b32 v25, v24
    s_branch L_qgot
L_P1:
    s_add_u32 s76, s54, 0
    s_add_u32 s77, s54, 4096
    s_add_u32 s60, s54, 57344
    s_waitcnt vmcnt(0)
    s_mov_b32 s52, s3
Lcg_8:
    buffer_load_dwordx4 v[196:199], v9, s[28:31], s76 offen offset:0 sc1
    buffer_load_dwordx4 v[200:203], v9, s[28:31], s76 offen offset:1024 sc1
    buffer_load_dwordx4 v[204:207], v9, s[28:31], s76 offen offset:2048 sc1
    buffer_load_dwordx4 v[208:211], v9, s[28:31], s76 offen offset:3072 sc1
    buffer_load_dwordx4 v[228:231], v9, s[28:31], s60 offen sc1
    buffer_load_dwordx4 v[232:235], v9, s[28:31], s60 offen offset:1024 sc1
    buffer_load_dwordx4 v[212:215], v9, s[28:31], s77 offen offset:0 sc1
    buffer_load_dwordx4 v[216:219], v9, s[28:31], s77 offen offset:1024 sc1
    buffer_load_dwordx4 v[220:223], v9, s[28:31], s77 offen offset:2048 sc1
    buffer_load_dwordx4 v[224:227], v9, s[28:31], s77 offen offset:3072 sc1
    s_waitcnt vmcnt(9)
    v_max3_u32 v31, v196, v197, v198
    v_max_u32 v31, v31, v199
    v_mfma_f32_16x16x32_bf16 v[236:239], v[96:99], v[196:199], 0
    v_mfma_f32_16x16x32_bf16 v[240:243], v[100:103], v[196:199], 0
    s_waitcnt vmcnt(8)
    v_max3_u32 v31, v31, v200, v201
    v_max3_u32 v31, v31, v202, v203
    v_mfma_f32_16x16x32_bf16 v[236:239], v[104:107], v[200:203], v[236:239]
    v_mfma_f32_16x16x32_bf16 v[240:243], v[108:111], v[200:203], v[240:243]
    s_waitcnt vmcnt(7)
    v_max3_u32 v31, v31, v204, v205
    v_max3_u32 v31, v31, v206, v207
    v_mfma_f32_16x16x32_bf16 v[236:239], v[112:115], v[204:207], v[236:239]
    v_mfma_f32_16x16x32_bf16 v[240:243], v[116:119], v[204:207], v[240:243]
    s_waitcnt vmcnt(6)
    v_max3_u32 v31, v31, v208, v209
    v_max3_u32 v31, v31, v210, v211
    v_mfma_f32_16x16x32_bf16 v[236:239], v[120:123], v[208:211], v[236:239]
    v_mfma_f32_16x16x32_bf16 v[240:243], v[124:127], v[208:211], v[240:243]
    s_waitcnt vmcnt(3)
    v_max3_u32 v31, v31, v212, v213
    v_max3_u32 v31, v31, v214, v215
    v_mfma_f32_16x16x32_bf16 v[236:239], v[128:131], v[212:215], v[236:239]
    v_add_f32 v24, v228, v229
    v_add_f32 v25, v230, v231
    v_add_f32 v26, v232, v233
    v_mfma_f32_16x16x32_bf16 v[240:243], v[132:135], v[212:215], v[240:243]
    v_add_f32 v27, v234, v235
    v_max3_u32 v29, v228, v229, v230
    v_add_f32 v24, v24, v25
    s_waitcnt vmcnt(2)
    v_max3_u32 v31, v31, v216, v217
    v_max3_u32 v31, v31, v218, v219
    v_mfma_f32_16x16x32_bf16 v[236:239], v[136:139], v[216:219], v[236:239]
    v_add_f32 v26, v26, v27
    v_max3_u32 v29, v29, v231, v232
    v_add_f32 v24, v24, v26
    v_mfma_f32_16x16x32_bf16 v[240:243], v[140:143], v[216:219], v[240:243]
    v_max3_u32 v29, v29, v233, v234
    v_mov_b32 v25, v24
    v_max_u32 v29, v29, v235
    s_waitcnt vmcnt(1)
    v_max3_u32 v31, v31, v220, v221
    v_max3_u32 v31, v31, v222, v223
    v_mfma_f32_16x16x32_bf16 v[236:239], v[144:147], v[220:223], v[236:239]
    v_permlane16_swap_b32 v24, v25
    v_add_f32 v24, v24, v25
    v_mov_b32 v25, v24
    v_mfma_f32_16x16x32_bf16 v[240:243], v[148:151], v[220:223], v[240:243]
    s_nop 0
    v_permlane32_swap_b32 v24, v25
    v_add_f32 v24, v24, v25
    s_nop 1
    v_mov_b32_dpp v26, v24 row_ror:8 row_mask:0xf bank_mask:0xf
    s_waitcnt vmcnt(0)
    v_max3_u32 v31, v31, v224, v225
    v_max3_u32 v31, v31, v226, v227
    v_mfma_f32_16x16x32_bf16 v[236:239], v[152:155], v[224:227], v[236:239]
    v_mul_f32 v27, 0x3b000000, v24
    v_mul_f32 v26, 0x3b000000, v26
    v_fma_f32 v26, -v27, v27, v26
    v_mfma_f32_16x16x32_bf16 v[240:243], v[156:159], v[224:227], v[240:243]
    v_max_f32 v26, 0, v26
    v_add_f32 v26, 0x3727c5ac, v26
    v_rsq_f32 v28, v26
    v_max_u32 v31, v31, v29
    v_cmp_eq_u32 vcc, -1, v31
    s_cbranch_vccz Lcd_9
    s_sub_u32 s52, s52, 1
    s_cbranch_scc0 Lcg_8
    s_mov_b32 s3, 0
Lcd_9:
    s_nop 1
    v_add_f32_dpp v236, v240, v236 row_ror:8 row_mask:0xf bank_mask:0xf
    v_add_f32_dpp v237, v241, v237 row_ror:8 row_mask:0xf bank_mask:0xf
    v_add_f32_dpp v238, v242, v238 row_ror:8 row_mask:0xf bank_mask:0xf
    v_add_f32_dpp v239, v243, v239 row_ror:8 row_mask:0xf bank_mask:0xf
    v_fma_f32 v236, -v27, v188, v236
    v_fma_f32 v237, -v27, v189, v237
    v_fma_f32 v238, -v27, v190, v238
    v_fma_f32 v239, -v27, v191, v239
    v_mul_f32 v236, v236, v28
    v_mul_f32 v237, v237, v28
    v_mul_f32 v238, v238, v28
    v_mul_f32 v239, v239, v28
    v_cvt_pk_bf16_f32 v24, v236, v237
    v_cvt_pk_bf16_f32 v25, v238, v239
    v_min_u32 v24, -2, v24
    v_min_u32 v25, -2, v25
    s_mov_b64 exec, s[64:65]
    s_cmp_eq_u32 s51, 0
    s_cbranch_scc1 Lpub_10
    buffer_store_dwordx2 v[24:25], v8, s[28:31], s79 offen
    s_branch Lpub_11
Lpub_10:
    buffer_store_dwordx2 v[24:25], v8, s[28:31], s79 offen sc1
Lpub_11:
    s_mov_b64 exec, -1
    s_lshr_b32 s60, s50, 2
    s_lshl_b32 s60, s60, 10
    s_add_u32 s59, s79, s60
    s_waitcnt vmcnt(0)
    s_mov_b32 s52, s3
Lpoll_12:
    buffer_load_dwordx4 v[204:207], v9, s[28:31], s59 offen sc1
    s_waitcnt vmcnt(0)
    v_max3_u32 v31, v204, v205, v206
    v_max_u32 v31, v31, v207
    v_cmp_eq_u32 vcc, -1, v31
    s_cbranch_vccz Lpd_13
    s_sub_u32 s52, s52, 1
    s_cbranch_scc0 Lpoll_12
    s_mov_b32 s3, 0
Lpd_13:
L_qgot:
    v_mul_u32_u24 v24, 320, v3
    v_lshl_add_u32 v24, v2, 4, v24
    v_add_u32 v24, 147456, v24
    ds_write_b128 v24, v[204:207]
    s_cmp_eq_u32 s53, 0
    s_cbranch_scc0 L_barA
    s_mul_i32 s57, s49, 163840
    s_mul_i32 s58, s50, 5120
    s_add_u32 s57, s57, s58
    s_add_u32 s58, s57, 4096
    buffer_load_dwordx4 v[160:163], v9, s[28:31], s57 offen offset:0 sc1
    buffer_load_dwordx4 v[164:167], v9, s[28:31], s57 offen offset:1024 sc1
    buffer_load_dwordx4 v[168:171], v9, s[28:31], s57 offen offset:2048 sc1
    buffer_load_dwordx4 v[172:175], v9, s[28:31], s57 offen offset:3072 sc1
    buffer_load_dwordx4 v[176:179], v9, s[28:31], s58 offen sc1
    s_cmp_eq_u32 s50, 0
    s_cbranch_scc0 L_barA
    s_mov_b32 s52, 2000000
    s_lshl_b32 s62, s49, 5
Lgp_14:
    v_lshlrev_b32 v25, 2, v1
    s_mov_b64 exec, 0xff
    buffer_load_dword v26, v25, s[40:43], s62 offen sc1
    s_waitcnt vmcnt(0)
    v_and_b32 v27, 0x20202020, v26
    v_cmp_ne_u32 vcc, 0x20202020, v27
    s_mov_b64 exec, -1
    s_cbranch_vccz Lgd_15
    s_sub_u32 s52, s52, 1
    s_cbranch_scc0 Lgp_14
Lgd_15:
    s_or_b32 s85, s85, 0x40
    v_mov_b32 v29, 159756
    s_mov_b32 s52, 2000000
L_w12c:
    ds_read_b32 v28, v29
    s_waitcnt lgkmcnt(0)
    v_readfirstlane_b32 s58, v28
    s_nop 0
    s_cmp_eq_u32 s58, 1
    s_cbranch_scc1 L_w12c_d
    s_sub_u32 s52, s52, 1
    s_cbranch_scc0 L_w12c
L_w12c_d:
    s_lshl_b32 s61, s49, 5
    s_add_u32 s61, s61, s50
    v_mov_b32 v24, s85
    v_mov_b32 v25, 0
    s_mov_b64 exec, 1
    buffer_store_byte v24, v25, s[40:43], s61 offen sc1
    s_mov_b64 exec, -1
L_barA:
    s_cmp_eq_u32 s53, 0
    s_cbranch_scc1 L_barA0
    s_waitcnt vmcnt(0)
L_barA0:
    s_waitcnt lgkmcnt(0)
    s_barrier
    ds_read_b128 v[228:231], v17 offset:0
    ds_read_b128 v[232:235], v17 offset:64
    ds_read_b128 v[236:239], v17 offset:128
    ds_read_b128 v[240:243], v17 offset:192
    s_cmp_eq_u32 s53, 0
    s_cbranch_scc0 L_kdone
    v_mov_b32 v25, 159744
    ds_read_b32 v26, v25
    v_xor_b32 v24, 0, v21
    ds_read_b128 v[32:35], v24 offset:0
    ds_read_b128 v[48:51], v24 offset:4096
    v_xor_b32 v24, 64, v21
    ds_read_b128 v[36:39], v24 offset:0
    ds_read_b128 v[52:55], v24 offset:4096
    v_xor_b32 v24, 128, v21
    ds_read_b128 v[40:43], v24 offset:0
    ds_read_b128 v[56:59], v24 offset:4096
    v_xor_b32 v24, 192, v21
    ds_read_b128 v[44:47], v24 offset:0
    ds_read_b128 v[60:63], v24 offset:4096
    s_waitcnt lgkmcnt(0)
    v_readfirstlane_b32 s51, v26
    s_branch L_k2
L_kdone:
L_k2:
    s_waitcnt lgkmcnt(3)
    v_mfma_f32_16x16x32_bf16 v[244:247], v[32:35], v[228:231], 0
    v_mfma_f32_16x16x32_bf16 v[248:251], v[48:51], v[228:231], 0
    s_waitcnt lgkmcnt(2)
    v_mfma_f32_16x16x32_bf16 v[244:247], v[36:39], v[232:235], v[244:247]
    v_mfma_f32_16x16x32_bf16 v[248:251], v[52:55], v[232:235], v[248:251]
    s_waitcnt lgkmcnt(1)
    v_mfma_f32_16x16x32_bf16 v[244:247], v[40:43], v[236:239], v[244:247]
    v_mfma_f32_16x16x32_bf16 v[248:251], v[56:59], v[236:239], v[248:251]
    s_waitcnt lgkmcnt(0)
    v_mfma_f32_16x16x32_bf16 v[244:247], v[44:47], v[240:243], v[244:247]
    v_mfma_f32_16x16x32_bf16 v[248:251], v[60:63], v[240:243], v[248:251]
    s_lshl_b32 s57, s48, 2
    v_add_u32 v26, s57, v22
    s_nop 4
    v_max3_f32 v24, v244, v245, v246
    v_max3_f32 v25, v248, v249, v250
    v_max3_f32 v24, v24, v247, v251
    v_max_f32 v24, v24, v25
    v_mov_b32 v25, v24
    s_nop 1
    v_permlane16_swap_b32 v24, v25
    v_max_f32 v24, v24, v25
    v_mov_b32 v25, v24
    s_nop 1
    v_permlane32_swap_b32 v24, v25
    v_max_f32 v24, v24, v25
    s_mov_b64 exec, 15
    ds_write_b32 v26, v24
    s_mov_b64 exec, -1
    v_cndmask_b32 v228, v244, v246, s[14:15]
    v_cndmask_b32 v229, v245, v247, s[14:15]
    v_cndmask_b32 v230, v248, v250, s[14:15]
    v_cndmask_b32 v231, v249, v251, s[14:15]
    v_cndmask_b32 v228, v228, v230, s[70:71]
    v_cndmask_b32 v229, v229, v231, s[70:71]
    s_waitcnt lgkmcnt(0)
    s_barrier
    ds_read_b128 v[196:199], v22
    ds_read_b128 v[200:203], v22 offset:16
    s_mov_b32 s57, 0x3e0293ee
    s_lshl_b32 s58, s48, 8
    v_and_b32 v29, 12, v2
    v_add3_u32 v29, s58, v20, v29
    s_waitcnt lgkmcnt(0)
    v_max3_f32 v27, v196, v197, v198
    v_max3_f32 v25, v200, v201, v202
    v_max3_f32 v27, v27, v199, v203
    v_max_f32 v27, v27, v25
    v_mul_f32 v27, s57, v27
    v_fma_f32 v228, v228, s57, -v27
    v_fma_f32 v229, v229, s57, -v27
    v_exp_f32 v228, v228
    v_exp_f32 v229, v229
    s_nop 0
    v_cvt_pk_bf16_f32 v230, v228, v229
    ds_write_b32 v29, v230
    v_add_f32 v28, v228, v229
    s_nop 1
    v_add_f32_dpp v28, v28, v28 row_ror:4 row_mask:0xf bank_mask:0xf
    s_nop 1
    v_add_f32_dpp v28, v28, v28 row_ror:8 row_mask:0xf bank_mask:0xf
    v_mov_b32 v25, v28
    s_nop 1
    v_permlane16_swap_b32 v28, v25
    v_add_f32 v28, v28, v25
    v_mov_b32 v25, v28
    s_nop 1
    v_permlane32_swap_b32 v28, v25
    v_add_f32 v28, v28, v25
    s_mov_b64 exec, 15
    ds_write_b32 v26, v28 offset:128
    s_mov_b64 exec, -1
    s_cmp_eq_u32 s53, 0
    s_cbranch_scc0 L_nov
    s_waitcnt vmcnt(2)
L_nov:
    s_waitcnt lgkmcnt(0)
    s_barrier
    ds_read_b128 v[196:199], v20 offset:0
    ds_read_b128 v[200:203], v20 offset:256
    ds_read_b128 v[204:207], v20 offset:512
    ds_read_b128 v[208:211], v20 offset:768
    ds_read_b128 v[212:215], v20 offset:1024
    ds_read_b128 v[216:219], v20 offset:1280
    ds_read_b128 v[220:223], v20 offset:1536
    ds_read_b128 v[224:227], v20 offset:1792
    s_cmp_eq_u32 s53, 0
    s_cbranch_scc0 L_vdone
    ds_read_b64_tr_b16 v[64:65], v18 offset:0
    ds_read_b64_tr_b16 v[66:67], v18 offset:4096
    ds_read_b64_tr_b16 v[68:69], v18 offset:8192
    ds_read_b64_tr_b16 v[70:71], v18 offset:12288
    ds_read_b64_tr_b16 v[72:73], v18 offset:16384
    ds_read_b64_tr_b16 v[74:75], v18 offset:20480
    ds_read_b64_tr_b16 v[76:77], v18 offset:24576
    ds_read_b64_tr_b16 v[78:79], v18 offset:28672
    ds_read_b64_tr_b16 v[80:81], v18 offset:32768
    ds_read_b64_tr_b16 v[82:83], v18 offset:36864
    ds_read_b64_tr_b16 v[84:85], v18 offset:40960
    ds_read_b64_tr_b16 v[86:87], v18 offset:45056
    ds_read_b64_tr_b16 v[88:89], v18 offset:49152
    ds_read_b64_tr_b16 v[90:91], v18 offset:53248
    ds_read_b64_tr_b16 v[92:93], v18 offset:57344
    ds_read_b64_tr_b16 v[94:95], v18 offset:61440
    s_waitcnt lgkmcnt(0)
L_vdone:
    s_lshr_b32 s57, s48, 2
    s_lshl_b32 s57, s57, 13
    s_and_b32 s58, s48, 1
    s_lshl_b32 s58, s58, 12
    s_add_u32 s57, s57, s58
    s_add_u32 s57, s57, 131072
    v_lshrrev_b32 v29, 2, v2
    v_lshl_add_u32 v29, v3, 2, v29
    v_lshlrev_b32 v29, 6, v29
    v_and_b32 v30, 1, v3
    v_lshl_add_u32 v29, v30, 5, v29
    v_and_b32 v30, 3, v2
    v_lshl_add_u32 v29, v30, 3, v29
    v_add_u32 v15, s57, v29
    v_xor_b32 v16, 32, v15
    s_waitcnt lgkmcnt(7)
    v_mfma_f32_16x16x32_bf16 v[244:247], v[64:67], v[196:199], 0
    s_waitcnt lgkmcnt(6)
    v_mfma_f32_16x16x32_bf16 v[244:247], v[68:71], v[200:203], v[244:247]
    s_waitcnt lgkmcnt(5)
    v_mfma_f32_16x16x32_bf16 v[244:247], v[72:75], v[204:207], v[244:247]
    s_waitcnt lgkmcnt(4)
    v_mfma_f32_16x16x32_bf16 v[244:247], v[76:79], v[208:211], v[244:247]
    s_waitcnt lgkmcnt(3)
    v_mfma_f32_16x16x32_bf16 v[244:247], v[80:83], v[212:215], v[244:247]
    s_waitcnt lgkmcnt(2)
    v_mfma_f32_16x16x32_bf16 v[244:247], v[84:87], v[216:219], v[244:247]
    s_waitcnt lgkmcnt(1)
    v_mfma_f32_16x16x32_bf16 v[244:247], v[88:91], v[220:223], v[244:247]
    s_waitcnt lgkmcnt(0)
    v_mfma_f32_16x16x32_bf16 v[244:247], v[92:95], v[224:227], v[244:247]
    s_cmp_eq_u32 s53, 0
    s_cbranch_scc1 L_nowo
    ds_read_b64_tr_b16 v[228:229], v15 offset:0
    ds_read_b64_tr_b16 v[230:231], v15 offset:1024
    ds_read_b64_tr_b16 v[232:233], v16 offset:0
    ds_read_b64_tr_b16 v[234:235], v16 offset:1024
    ds_read_b64_tr_b16 v[236:237], v15 offset:2048
    ds_read_b64_tr_b16 v[238:239], v15 offset:3072
    ds_read_b64_tr_b16 v[240:241], v16 offset:2048
    ds_read_b64_tr_b16 v[242:243], v16 offset:3072
L_nowo:
    s_add_u32 s59, s54, 24576
    s_nop 4
    v_cvt_pk_bf16_f32 v24, v244, v245
    v_cvt_pk_bf16_f32 v25, v246, v247
    v_min_u32 v24, -2, v24
    v_min_u32 v25, -2, v25
    s_mov_b64 exec, s[68:69]
    s_cmp_eq_u32 s51, 0
    s_cbranch_scc1 Lpub_17
    buffer_store_dwordx2 v[24:25], v10, s[28:31], s59 offen
    s_branch Lpub_18
Lpub_17:
    buffer_store_dwordx2 v[24:25], v10, s[28:31], s59 offen sc1
Lpub_18:
    s_mov_b64 exec, -1
    s_cmp_eq_u32 s48, 2
    s_cbranch_scc0 L_noml
    ds_read_b128 v[196:199], v22 offset:128
    ds_read_b128 v[200:203], v22 offset:144
    s_bfe_u32 s57, s50, 0x10001
    s_lshl_b32 s57, s57, 7
    s_lshr_b32 s58, s50, 2
    s_lshl_b32 s58, s58, 4
    s_add_u32 s57, s57, s58
    s_and_b32 s58, s50, 1
    s_lshl_b32 s58, s58, 3
    s_add_u32 s57, s57, s58
    s_add_u32 s57, s57, s54
    s_add_u32 s57, s57, 61440
    v_lshlrev_b32 v26, 8, v1
    s_waitcnt lgkmcnt(0)
    v_add_f32 v196, v196, v197
    v_add_f32 v198, v198, v199
    v_add_f32 v200, v200, v201
    v_add_f32 v202, v202, v203
    v_add_f32 v196, v196, v198
    v_add_f32 v200, v200, v202
    v_add_f32 v29, v196, v200
    v_min_u32 v28, -2, v27
    v_min_u32 v29, -2, v29
    s_mov_b64 exec, 15
    s_cmp_eq_u32 s51, 0
    s_cbranch_scc1 Lpub_19
    buffer_store_dwordx2 v[28:29], v26, s[28:31], s57 offen
    s_branch Lpub_20
Lpub_19:
    buffer_store_dwordx2 v[28:29], v26, s[28:31], s57 offen sc1
Lpub_20:
    s_mov_b64 exec, -1
L_noml:
    s_waitcnt vmcnt(0)
    s_barrier
    s_cmp_eq_u32 s53, 0
    s_cbranch_scc0 L_wo2
    ds_read_b64_tr_b16 v[228:229], v15 offset:0
    ds_read_b64_tr_b16 v[230:231], v15 offset:1024
    ds_read_b64_tr_b16 v[232:233], v16 offset:0
    ds_read_b64_tr_b16 v[234:235], v16 offset:1024
    ds_read_b64_tr_b16 v[236:237], v15 offset:2048
    ds_read_b64_tr_b16 v[238:239], v15 offset:3072
    ds_read_b64_tr_b16 v[240:241], v16 offset:2048
    ds_read_b64_tr_b16 v[242:243], v16 offset:3072
L_wo2:
    s_add_u32 s59, s54, s78
    s_add_u32 s59, s59, 24576
    s_add_u32 s60, s54, 61440
    v_lshlrev_b32 v30, 5, v1
    v_and_b32 v30, 0xff, v30
    s_mov_b32 s52, s3
Lpoll_21:
    buffer_load_dwordx4 v[196:199], v9, s[28:31], s59 offen sc1
    buffer_load_dwordx4 v[200:203], v9, s[28:31], s59 offen offset:1024 sc1
    s_mov_b64 exec, 0xffff
    buffer_load_dwordx4 v[204:207], v11, s[28:31], s60 offen sc1
    buffer_load_dwordx4 v[208:211], v11, s[28:31], s60 offen offset:128 sc1
    s_mov_b64 exec, 0xff
    buffer_load_dword v224, v30, s[40:43], 0 offen sc1
    s_mov_b64 exec, -1
    s_waitcnt vmcnt(0)
    v_max3_u32 v31, v196, v197, v198
    v_max3_u32 v31, v31, v199, v200
    v_max3_u32 v31, v31, v201, v202
    v_max_u32 v31, v31, v203
    v_cmp_eq_u32 vcc, -1, v31
    v_max3_u32 v29, v204, v205, v206
    v_max3_u32 v29, v29, v207, v208
    v_max3_u32 v29, v29, v209, v210
    v_max_u32 v29, v29, v211
    v_cmp_eq_u32 s[72:73], -1, v29
    s_nop 0
    s_and_b64 s[72:73], s[72:73], 0xffff
    s_or_b64 vcc, vcc, s[72:73]
    v_and_b32 v29, 0x40, v224
    v_cmp_eq_u32 s[72:73], 0, v29
    s_nop 0
    s_and_b64 s[72:73], s[72:73], 0xff
    s_or_b64 vcc, vcc, s[72:73]
    s_cbranch_vccz Lpd_22
    s_sub_u32 s52, s52, 1
    s_cbranch_scc0 Lpoll_21
    s_mov_b32 s3, 0
Lpd_22:
    s_cmp_eq_u32 s53, 0
    s_cbranch_scc0 L_havewo
    s_cmp_lt_u32 s48, 2
    s_cbranch_scc1 L_havewo
    s_sub_u32 s88, s48, 2
    s_mul_i32 s57, s49, 224
    s_mul_i32 s58, s50, 7
    s_add_u32 s57, s57, s58
    s_lshl_b32 s57, s57, 10
    s_mov_b32 s32, s20
    s_mov_b32 s33, s21
    s_mov_b32 s34, 1835008
    s_mov_b32 s35, 0x20000
    s_lshl_b32 s58, s88, 10
    s_add_u32 s58, s58, s57
    buffer_load_dwordx4 v[96:99], v9, s[32:35], s58 offen
    s_cmp_eq_u32 s88, 0
    s_cbranch_scc0 L_pf1
    s_add_u32 s58, s57, 6144
    buffer_load_dwordx4 v[100:103], v9, s[32:35], s58 offen
L_pf1:
    s_mov_b32 s36, s16
    s_mov_b32 s37, s17
    s_mov_b32 s38, 1835008
    s_mov_b32 s39, 0x20000
    s_mul_i32 s57, s50, 57344
    s_mul_i32 s58, s49, 448
    s_add_u32 s57, s57, s58
    s_mov_b32 s58, s88
    s_lshl_b32 s58, s58, 6
    v_add_u32 v29, s58, v1
    s_mov_b32 s59, 2341
    v_mul_u32_u24 v30, s59, v29
    v_lshrrev_b32 v30, 16, v30
    v_mul_u32_u24 v28, 28, v30
    v_sub_u32 v28, v29, v28
    s_mov_b32 s59, 3584
    v_mul_u32_u24 v30, s59, v30
    v_lshl_add_u32 v30, v28, 4, v30
    buffer_load_dwordx4 v[104:107], v30, s[36:39], s57 offen
Lpf_23:
    s_cmp_eq_u32 s88, 0
    s_cbranch_scc0 Lpf_24
    s_mov_b32 s58, 6
    s_lshl_b32 s58, s58, 6
    v_add_u32 v29, s58, v1
    s_mov_b32 s59, 2341
    v_mul_u32_u24 v30, s59, v29
    v_lshrrev_b32 v30, 16, v30
    v_mul_u32_u24 v28, 28, v30
    v_sub_u32 v28, v29, v28
    s_mov_b32 s59, 3584
    v_mul_u32_u24 v30, s59, v30
    v_lshl_add_u32 v30, v28, 4, v30
    buffer_load_dwordx4 v[108:111], v30, s[36:39], s57 offen
Lpf_24:
L_havewo:
    s_waitcnt lgkmcnt(0)
    v_mfma_f32_16x16x32_bf16 v[212:215], v[228:231], v[196:199], 0
    v_mfma_f32_16x16x32_bf16 v[216:219], v[232:235], v[196:199], 0
    v_mfma_f32_16x16x32_bf16 v[212:215], v[236:239], v[200:203], v[212:215]
    v_mfma_f32_16x16x32_bf16 v[216:219], v[240:243], v[200:203], v[216:219]
    v_max3_f32 v24, v204, v206, v208
    v_max_f32 v24, v24, v210
    v_sub_f32 v220, v204, v24
    v_sub_f32 v221, v206, v24
    v_sub_f32 v222, v208, v24
    v_sub_f32 v223, v210, v24
    v_exp_f32 v220, v220
    v_exp_f32 v221, v221
    v_exp_f32 v222, v222
    v_exp_f32 v223, v223
    s_bitcmp1_b32 s48, 1
    s_cselect_b64 s[74:75], -1, 0
    v_mul_f32 v25, v220, v205
    v_fmac_f32 v25, v221, v207
    v_fmac_f32 v25, v222, v209
    v_fmac_f32 v25, v223, v211
    v_cndmask_b32 v27, v220, v222, s[74:75]
    v_rcp_f32 v25, v25
    v_cndmask_b32 v28, v221, v223, s[74:75]
    v_cndmask_b32 v26, v27, v28, s[70:71]
    v_mul_f32 v26, v26, v25
    v_mov_b32 v28, v26
    s_nop 1
    v_permlane16_swap_b32 v26, v28
    v_mov_b32 v28, v26
    s_nop 1
    v_permlane32_swap_b32 v26, v28
    s_lshl_b32 s57, s48, 10
    s_add_u32 s57, s57, 151552
    v_add_u32 v27, s57, v9
    v_mul_f32 v212, v212, v26
    v_mul_f32 v213, v213, v26
    v_mul_f32 v214, v214, v26
    v_mul_f32 v215, v215, v26
    v_mul_f32 v216, v216, v26
    v_mul_f32 v217, v217, v26
    v_mul_f32 v218, v218, v26
    v_mul_f32 v219, v219, v26
    v_add_f32_dpp v212, v212, v212 row_ror:8 row_mask:0xf bank_mask:0xf
    v_add_f32_dpp v213, v213, v213 row_ror:8 row_mask:0xf bank_mask:0xf
    v_add_f32_dpp v214, v214, v214 row_ror:8 row_mask:0xf bank_mask:0xf
    v_add_f32_dpp v215, v215, v215 row_ror:8 row_mask:0xf bank_mask:0xf
    v_add_f32_dpp v216, v216, v216 row_ror:8 row_mask:0xf bank_mask:0xf
    v_add_f32_dpp v217, v217, v217 row_ror:8 row_mask:0xf bank_mask:0xf
    v_add_f32_dpp v218, v218, v218 row_ror:8 row_mask:0xf bank_mask:0xf
    v_add_f32_dpp v219, v219, v219 row_ror:8 row_mask:0xf bank_mask:0xf
    v_cndmask_b32 v212, v212, v216, s[70:71]
    v_cndmask_b32 v213, v213, v217, s[70:71]
    v_cndmask_b32 v214, v214, v218, s[70:71]
    v_cndmask_b32 v215, v215, v219, s[70:71]
    ds_write_b128 v27, v[212:215]
    s_waitcnt lgkmcnt(0)
    s_barrier
    s_cmp_eq_u32 s48, 0
    s_cbranch_scc1 L_w0path
    s_cmp_eq_u32 s53, 1
    s_cbranch_scc0 L_stage12
    s_cmp_eq_u32 s48, 2
    s_cbranch_scc1 L_w2go
    s_cmp_eq_u32 s48, 1
    s_cbranch_scc1 L_GX
    s_branch L_fin
L_stage12:
    s_cmp_eq_u32 s48, 1
    s_cbranch_scc1 L_GX
    s_sub_u32 s88, s48, 2
    s_waitcnt vmcnt(0)
    s_lshl_b32 s88, s88, 2
    s_cmp_lt_u32 s88, 16
    s_cbranch_scc0 L_st_w2
    s_cmp_lt_u32 s50, 14
    s_cbranch_scc0 L_st_wait
    s_mul_i32 s57, s49, 448
    s_lshl_b32 s58, s50, 5
    s_add_u32 s57, s57, s58
    s_add_u32 s36, s16, s57
    s_addc_u32 s37, s17, 0
    s_sub_u32 s38, 1835008, s57
    s_mov_b32 s39, 0x20000
    v_lshrrev_b32 v24, 1, v1
    v_lshrrev_b32 v25, 4, v24
    v_bfe_u32 v26, v24, 2, 2
    v_lshlrev_b32 v26, 3, v26
    v_lshl_add_u32 v26, v25, 2, v26
    v_and_b32 v24, 3, v24
    v_add_u32 v26, v26, v24
    s_mov_b32 s61, 3584
    v_mul_lo_u32 v26, v26, s61
    v_and_b32 v24, 1, v1
    v_lshl_add_u32 v30, v24, 4, v26
    s_add_u32 s59, s88, 0
    s_mul_i32 s60, s59, 114688
    s_lshl_b32 s59, s59, 10
    s_add_u32 m0, s59, 0
    s_nop 0
    buffer_load_dwordx4 v30, s[36:39], s60 offen lds
    s_add_u32 s59, s88, 1
    s_mul_i32 s60, s59, 114688
    s_lshl_b32 s59, s59, 10
    s_add_u32 m0, s59, 0
    s_nop 0
    buffer_load_dwordx4 v30, s[36:39], s60 offen lds
    s_add_u32 s59, s88, 2
    s_mul_i32 s60, s59, 114688
    s_lshl_b32 s59, s59, 10
    s_add_u32 m0, s59, 0
    s_nop 0
    buffer_load_dwordx4 v30, s[36:39], s60 offen lds
    s_add_u32 s59, s88, 3
    s_mul_i32 s60, s59, 114688
    s_lshl_b32 s59, s59, 10
    s_add_u32 m0, s59, 0
    s_nop 0
    buffer_load_dwordx4 v30, s[36:39], s60 offen lds
    s_branch L_st_wait
L_st_w2:
    s_mul_i32 s57, s49, 229376
    s_lshl_b32 s58, s50, 5
    s_add_u32 s57, s57, s58
    s_add_u32 s36, s20, s57
    s_addc_u32 s37, s21, 0
    s_sub_u32 s38, 1835008, s57
    s_mov_b32 s39, 0x20000
    v_lshrrev_b32 v24, 1, v1
    v_lshrrev_b32 v25, 4, v24
    v_bfe_u32 v26, v24, 2, 2
    v_lshlrev_b32 v26, 3, v26
    v_lshl_add_u32 v26, v25, 2, v26
    v_and_b32 v24, 3, v24
    v_add_u32 v26, v26, v24
    s_mov_b32 s61, 1024
    v_mul_lo_u32 v26, v26, s61
    v_and_b32 v24, 1, v1
    v_lshl_add_u32 v30, v24, 4, v26
    s_sub_u32 s88, s88, 16
    s_add_u32 s59, s88, 0
    s_cmp_lt_u32 s59, 7
    s_cbranch_scc0 Lw2_25
    s_lshl_b32 s60, s59, 15
    s_lshl_b32 s59, s59, 10
    s_add_u32 m0, s59, 16384
    s_nop 0
    buffer_load_dwordx4 v30, s[36:39], s60 offen lds
Lw2_25:
    s_add_u32 s59, s88, 1
    s_cmp_lt_u32 s59, 7
    s_cbranch_scc0 Lw2_26
    s_lshl_b32 s60, s59, 15
    s_lshl_b32 s59, s59, 10
    s_add_u32 m0, s59, 16384
    s_nop 0
    buffer_load_dwordx4 v30, s[36:39], s60 offen lds
Lw2_26:
    s_add_u32 s59, s88, 2
    s_cmp_lt_u32 s59, 7
    s_cbranch_scc0 Lw2_27
    s_lshl_b32 s60, s59, 15
    s_lshl_b32 s59, s59, 10
    s_add_u32 m0, s59, 16384
    s_nop 0
    buffer_load_dwordx4 v30, s[36:39], s60 offen lds
Lw2_27:
    s_add_u32 s59, s88, 3
    s_cmp_lt_u32 s59, 7
    s_cbranch_scc0 Lw2_28
    s_lshl_b32 s60, s59, 15
    s_lshl_b32 s59, s59, 10
    s_add_u32 m0, s59, 16384
    s_nop 0
    buffer_load_dwordx4 v30, s[36:39], s60 offen lds
Lw2_28:
L_st_wait:
    s_cmp_eq_u32 s48, 2
    s_cbranch_scc1 L_w2prep
    s_waitcnt vmcnt(0)
    v_mov_b32 v28, 1
    v_mov_b32 v29, 159772
    s_mov_b64 exec, 1
    ds_add_u32 v29, v28
    s_mov_b64 exec, -1
    s_branch L_GX
L_w0path:
    v_add_u32 v27, 151552, v9
    ds_read_b128 v[196:199], v27 offset:0
    ds_read_b128 v[200:203], v27 offset:1024
    ds_read_b128 v[204:207], v27 offset:2048
    ds_read_b128 v[208:211], v27 offset:3072
    ds_read_b128 v[212:215], v27 offset:4096
    ds_read_b128 v[216:219], v27 offset:5120
    ds_read_b128 v[220:223], v27 offset:6144
    ds_read_b128 v[224:227], v27 offset:7168
    s_waitcnt lgkmcnt(6)
    v_pk_add_f32 v[196:197], v[196:197], v[200:201]
    v_pk_add_f32 v[198:199], v[198:199], v[202:203]
    s_waitcnt lgkmcnt(4)
    v_pk_add_f32 v[204:205], v[204:205], v[208:209]
    v_pk_add_f32 v[206:207], v[206:207], v[210:211]
    s_waitcnt lgkmcnt(2)
    v_pk_add_f32 v[212:213], v[212:213], v[216:217]
    v_pk_add_f32 v[214:215], v[214:215], v[218:219]
    s_waitcnt lgkmcnt(0)
    v_pk_add_f32 v[220:221], v[220:221], v[224:225]
    v_pk_add_f32 v[222:223], v[222:223], v[226:227]
    v_pk_add_f32 v[196:197], v[196:197], v[204:205]
    v_pk_add_f32 v[198:199], v[198:199], v[206:207]
    v_pk_add_f32 v[212:213], v[212:213], v[220:221]
    v_pk_add_f32 v[214:215], v[214:215], v[222:223]
    v_pk_add_f32 v[196:197], v[196:197], v[212:213]
    v_pk_add_f32 v[198:199], v[198:199], v[214:215]
    v_min_u32 v196, -2, v196
    v_min_u32 v197, -2, v197
    v_min_u32 v198, -2, v198
    v_min_u32 v199, -2, v199
    buffer_store_dwordx4 v[196:199], v12, s[28:31], s55 offen sc1
    s_lshl_b32 s57, s50, 13
    s_add_u32 s57, s57, s55
    s_add_u32 s58, s57, 4096
    ds_read_b128 v[228:231], v23
    s_waitcnt vmcnt(0)
    s_mov_b32 s52, s3
Lpoll_29:
    buffer_load_dwordx4 v[196:199], v9, s[28:31], s57 offen offset:0 sc1
    buffer_load_dwordx4 v[200:203], v9, s[28:31], s57 offen offset:1024 sc1
    buffer_load_dwordx4 v[204:207], v9, s[28:31], s57 offen offset:2048 sc1
    buffer_load_dwordx4 v[208:211], v9, s[28:31], s57 offen offset:3072 sc1
    buffer_load_dwordx4 v[212:215], v9, s[28:31], s58 offen offset:0 sc1
    buffer_load_dwordx4 v[216:219], v9, s[28:31], s58 offen offset:1024 sc1
    buffer_load_dwordx4 v[220:223], v9, s[28:31], s58 offen offset:2048 sc1
    buffer_load_dwordx4 v[224:227], v9, s[28:31], s58 offen offset:3072 sc1
    s_waitcnt vmcnt(0)
    v_max3_u32 v31, v196, v197, v198
    v_max3_u32 v31, v31, v199, v200
    v_max3_u32 v31, v31, v201, v202
    v_max3_u32 v31, v31, v203, v204
    v_max3_u32 v31, v31, v205, v206
    v_max3_u32 v31, v31, v207, v208
    v_max3_u32 v31, v31, v209, v210
    v_max3_u32 v31, v31, v211, v212
    v_max3_u32 v31, v31, v213, v214
    v_max3_u32 v31, v31, v215, v216
    v_max3_u32 v31, v31, v217, v218
    v_max3_u32 v31, v31, v219, v220
    v_max3_u32 v31, v31, v221, v222
    v_max3_u32 v31, v31, v223, v224
    v_max3_u32 v31, v31, v225, v226
    v_max_u32 v31, v31, v227
    v_cmp_eq_u32 vcc, -1, v31
    s_cbranch_vccz Lpd_30
    s_sub_u32 s52, s52, 1
    s_cbranch_scc0 Lpoll_29
    s_mov_b32 s3, 0
Lpd_30:
    v_pk_add_f32 v[232:233], v[196:197], v[212:213]
    v_pk_add_f32 v[234:235], v[198:199], v[214:215]
    v_pk_add_f32 v[236:237], v[200:201], v[216:217]
    v_pk_add_f32 v[238:239], v[202:203], v[218:219]
    v_pk_add_f32 v[240:241], v[204:205], v[220:221]
    v_pk_add_f32 v[242:243], v[206:207], v[222:223]
    v_pk_add_f32 v[244:245], v[208:209], v[224:225]
    v_pk_add_f32 v[246:247], v[210:211], v[226:227]
    v_pk_add_f32 v[232:233], v[232:233], v[240:241]
    v_pk_add_f32 v[234:235], v[234:235], v[242:243]
    v_pk_add_f32 v[236:237], v[236:237], v[244:245]
    v_pk_add_f32 v[238:239], v[238:239], v[246:247]
    v_pk_add_f32 v[232:233], v[232:233], v[236:237]
    v_pk_add_f32 v[234:235], v[234:235], v[238:239]
    v_mov_b32 v236, v232
    v_mov_b32 v237, v233
    v_mov_b32 v238, v234
    v_mov_b32 v239, v235
    v_permlane32_swap_b32 v232, v236
    v_permlane32_swap_b32 v233, v237
    v_permlane32_swap_b32 v234, v238
    v_permlane32_swap_b32 v235, v239
    s_waitcnt lgkmcnt(0)
    v_add_f32 v232, v232, v236
    v_add_f32 v233, v233, v237
    v_add_f32 v234, v234, v238
    v_add_f32 v235, v235, v239
    v_add_f32 v232, v232, v228
    v_add_f32 v233, v233, v229
    v_add_f32 v234, v234, v230
    v_add_f32 v235, v235, v231
    s_add_u32 s59, s54, 8192
    s_add_u32 s60, s54, 59392
    v_cvt_pk_bf16_f32 v24, v232, v233
    v_cvt_pk_bf16_f32 v25, v234, v235
    v_min_u32 v24, -2, v24
    v_min_u32 v25, -2, v25
    s_mov_b64 exec, s[66:67]
    s_cmp_eq_u32 s51, 0
    s_cbranch_scc1 Lpub_31
    buffer_store_dwordx2 v[24:25], v6, s[28:31], s59 offen
    s_branch Lpub_32
Lpub_31:
    buffer_store_dwordx2 v[24:25], v6, s[28:31], s59 offen sc1
Lpub_32:
    s_mov_b64 exec, -1
    v_lshlrev_b32 v232, 16, v24
    v_and_b32 v233, 0xffff0000, v24
    v_lshlrev_b32 v234, 16, v25
    v_and_b32 v235, 0xffff0000, v25
    v_add_f32 v26, v232, v233
    v_add_f32 v28, v234, v235
    v_mul_f32 v27, v232, v232
    v_add_f32 v26, v26, v28
    v_fmac_f32 v27, v233, v233
    v_fmac_f32 v27, v234, v234
    v_fmac_f32 v27, v235, v235
    v_add_f32_dpp v26, v26, v26 row_ror:8 row_mask:0xf bank_mask:0xf
    s_nop 0
    v_add_f32_dpp v27, v27, v27 row_ror:8 row_mask:0xf bank_mask:0xf
    v_cndmask_b32 v26, v26, v27, s[70:71]
    v_mov_b32 v28, v26
    s_nop 1
    v_permlane16_swap_b32 v26, v28
    v_add_f32 v26, v26, v28
    v_min_u32 v26, -2, v26
    s_mov_b64 exec, 0xffff
    s_cmp_eq_u32 s51, 0
    s_cbranch_scc1 Lpub_33
    buffer_store_dword v26, v7, s[28:31], s60 offen
    s_branch Lpub_34
Lpub_33:
    buffer_store_dword v26, v7, s[28:31], s60 offen sc1
Lpub_34:
    s_mov_b64 exec, -1
    ds_write_b128 v23, v[232:235]
    s_waitcnt vmcnt(0)
L_GX:
    s_waitcnt lgkmcnt(0)
    s_barrier
    s_cmp_eq_u32 s48, 0
    s_cbranch_scc0 L_G1
    s_cmp_eq_u32 s53, 1
    s_cbranch_scc1 L_fin
    s_branch L_G1
L_w2prep:
    s_mul_i32 s57, s49, 448
    s_lshl_b32 s58, s50, 5
    s_add_u32 s57, s57, s58
    s_mov_b32 s32, s18
    s_mov_b32 s33, s19
    s_mov_b32 s34, 3584
    s_mov_b32 s35, 0x20000
    v_lshlrev_b32 v24, 3, v3
    buffer_load_dwordx2 v[26:27], v24, s[32:35], s57 offen
    s_waitcnt vmcnt(0)
    v_lshlrev_b32 v192, 16, v26
    v_and_b32 v193, 0xffff0000, v26
    v_lshlrev_b32 v194, 16, v27
    v_and_b32 v195, 0xffff0000, v27
    v_mov_b32 v29, 159772
    s_mov_b32 s52, 2000000
L_w28:
    ds_read_b32 v28, v29
    s_waitcnt lgkmcnt(0)
    v_readfirstlane_b32 s58, v28
    s_nop 0
    s_cmp_eq_u32 s58, 5
    s_cbranch_scc1 L_w28_d
    s_sub_u32 s52, s52, 1
    s_cbranch_scc0 L_w28
L_w28_d:
    v_add_u32 v24, 16384, v19
    ds_read_b64_tr_b16 v[160:161], v24 offset:0
    ds_read_b64_tr_b16 v[162:163], v24 offset:512
    ds_read_b64_tr_b16 v[164:165], v24 offset:1024
    ds_read_b64_tr_b16 v[166:167], v24 offset:1536
    ds_read_b64_tr_b16 v[168:169], v24 offset:2048
    ds_read_b64_tr_b16 v[170:171], v24 offset:2560
    ds_read_b64_tr_b16 v[172:173], v24 offset:3072
    ds_read_b64_tr_b16 v[174:175], v24 offset:3584
    ds_read_b64_tr_b16 v[176:177], v24 offset:4096
    ds_read_b64_tr_b16 v[178:179], v24 offset:4608
    ds_read_b64_tr_b16 v[180:181], v24 offset:5120
    ds_read_b64_tr_b16 v[182:183], v24 offset:5632
    ds_read_b64_tr_b16 v[184:185], v24 offset:6144
    ds_read_b64_tr_b16 v[186:187], v24 offset:6656
    v_add_u32 v24, 0, v19
    ds_read_b64_tr_b16 v[96:97], v24 offset:0
    ds_read_b64_tr_b16 v[98:99], v24 offset:512
    ds_read_b64_tr_b16 v[100:101], v24 offset:1024
    ds_read_b64_tr_b16 v[102:103], v24 offset:1536
    ds_read_b64_tr_b16 v[104:105], v24 offset:2048
    ds_read_b64_tr_b16 v[106:107], v24 offset:2560
    ds_read_b64_tr_b16 v[108:109], v24 offset:3072
    ds_read_b64_tr_b16 v[110:111], v24 offset:3584
    ds_read_b64_tr_b16 v[112:113], v24 offset:4096
    ds_read_b64_tr_b16 v[114:115], v24 offset:4608
    ds_read_b64_tr_b16 v[116:117], v24 offset:5120
    ds_read_b64_tr_b16 v[118:119], v24 offset:5632
    ds_read_b64_tr_b16 v[120:121], v24 offset:6144
    ds_read_b64_tr_b16 v[122:123], v24 offset:6656
    ds_read_b64_tr_b16 v[124:125], v24 offset:7168
    ds_read_b64_tr_b16 v[126:127], v24 offset:7680
    ds_read_b64_tr_b16 v[128:129], v24 offset:8192
    ds_read_b64_tr_b16 v[130:131], v24 offset:8704
    ds_read_b64_tr_b16 v[132:133], v24 offset:9216
    ds_read_b64_tr_b16 v[134:135], v24 offset:9728
    ds_read_b64_tr_b16 v[136:137], v24 offset:10240
    ds_read_b64_tr_b16 v[138:139], v24 offset:10752
    ds_read_b64_tr_b16 v[140:141], v24 offset:11264
    ds_read_b64_tr_b16 v[142:143], v24 offset:11776
    ds_read_b64_tr_b16 v[144:145], v24 offset:12288
    ds_read_b64_tr_b16 v[146:147], v24 offset:12800
    ds_read_b64_tr_b16 v[148:149], v24 offset:13312
    ds_read_b64_tr_b16 v[150:151], v24 offset:13824
    ds_read_b64_tr_b16 v[152:153], v24 offset:14336
    ds_read_b64_tr_b16 v[154:155], v24 offset:14848
    ds_read_b64_tr_b16 v[156:157], v24 offset:15360
    ds_read_b64_tr_b16 v[158:159], v24 offset:15872
    v_mov_b32 v196, 0x3f803f80
    v_mov_b32 v197, 0x3f803f80
    v_mov_b32 v198, 0x3f803f80
    v_mov_b32 v199, 0x3f803f80
    s_waitcnt lgkmcnt(0)
    s_nop 0
    v_mfma_f32_16x16x32_bf16 v[188:191], v[96:99], v[196:199], 0
    v_mfma_f32_16x16x32_bf16 v[188:191], v[100:103], v[196:199], v[188:191]
    v_mfma_f32_16x16x32_bf16 v[188:191], v[104:107], v[196:199], v[188:191]
    v_mfma_f32_16x16x32_bf16 v[188:191], v[108:111], v[196:199], v[188:191]
    v_mfma_f32_16x16x32_bf16 v[188:191], v[112:115], v[196:199], v[188:191]
    v_mfma_f32_16x16x32_bf16 v[188:191], v[116:119], v[196:199], v[188:191]
    v_mfma_f32_16x16x32_bf16 v[188:191], v[120:123], v[196:199], v[188:191]
    v_mfma_f32_16x16x32_bf16 v[188:191], v[124:127], v[196:199], v[188:191]
    v_mfma_f32_16x16x32_bf16 v[188:191], v[128:131], v[196:199], v[188:191]
    v_mfma_f32_16x16x32_bf16 v[188:191], v[132:135], v[196:199], v[188:191]
    v_mfma_f32_16x16x32_bf16 v[188:191], v[136:139], v[196:199], v[188:191]
    v_mfma_f32_16x16x32_bf16 v[188:191], v[140:143], v[196:199], v[188:191]
    v_mfma_f32_16x16x32_bf16 v[188:191], v[144:147], v[196:199], v[188:191]
    v_mfma_f32_16x16x32_bf16 v[188:191], v[148:151], v[196:199], v[188:191]
    v_mfma_f32_16x16x32_bf16 v[188:191], v[152:155], v[196:199], v[188:191]
    v_mfma_f32_16x16x32_bf16 v[188:191], v[156:159], v[196:199], v[188:191]
L_w2go:
    s_waitcnt lgkmcnt(0)
    s_barrier
    s_cmp_lt_u32 s50, 14
    s_cbranch_scc0 L_P6
    s_add_u32 s76, s54, 8192
    s_add_u32 s77, s54, 12288
    s_add_u32 s60, s54, 59392
    s_waitcnt vmcnt(0)
    s_mov_b32 s52, s3
Lcg_35:
    buffer_load_dwordx4 v[196:199], v9, s[28:31], s76 offen offset:0 sc1
    buffer_load_dwordx4 v[200:203], v9, s[28:31], s76 offen offset:1024 sc1
    buffer_load_dwordx4 v[204:207], v9, s[28:31], s76 offen offset:2048 sc1
    buffer_load_dwordx4 v[208:211], v9, s[28:31], s76 offen offset:3072 sc1
    buffer_load_dwordx4 v[228:231], v9, s[28:31], s60 offen sc1
    buffer_load_dwordx4 v[232:235], v9, s[28:31], s60 offen offset:1024 sc1
    buffer_load_dwordx4 v[212:215], v9, s[28:31], s77 offen offset:0 sc1
    buffer_load_dwordx4 v[216:219], v9, s[28:31], s77 offen offset:1024 sc1
    buffer_load_dwordx4 v[220:223], v9, s[28:31], s77 offen offset:2048 sc1
    buffer_load_dwordx4 v[224:227], v9, s[28:31], s77 offen offset:3072 sc1
    s_waitcnt vmcnt(9)
    v_max3_u32 v31, v196, v197, v198
    v_max_u32 v31, v31, v199
    v_mfma_f32_16x16x32_bf16 v[236:239], v[96:99], v[196:199], 0
    v_mfma_f32_16x16x32_bf16 v[240:243], v[100:103], v[196:199], 0
    s_waitcnt vmcnt(8)
    v_max3_u32 v31, v31, v200, v201
    v_max3_u32 v31, v31, v202, v203
    v_mfma_f32_16x16x32_bf16 v[236:239], v[104:107], v[200:203], v[236:239]
    v_mfma_f32_16x16x32_bf16 v[240:243], v[108:111], v[200:203], v[240:243]
    s_waitcnt vmcnt(7)
    v_max3_u32 v31, v31, v204, v205
    v_max3_u32 v31, v31, v206, v207
    v_mfma_f32_16x16x32_bf16 v[236:239], v[112:115], v[204:207], v[236:239]
    v_mfma_f32_16x16x32_bf16 v[240:243], v[116:119], v[204:207], v[240:243]
    s_waitcnt vmcnt(6)
    v_max3_u32 v31, v31, v208, v209
    v_max3_u32 v31, v31, v210, v211
    v_mfma_f32_16x16x32_bf16 v[236:239], v[120:123], v[208:211], v[236:239]
    v_mfma_f32_16x16x32_bf16 v[240:243], v[124:127], v[208:211], v[240:243]
    s_waitcnt vmcnt(3)
    v_max3_u32 v31, v31, v212, v213
    v_max3_u32 v31, v31, v214, v215
    v_mfma_f32_16x16x32_bf16 v[236:239], v[128:131], v[212:215], v[236:239]
    v_add_f32 v24, v228, v229
    v_add_f32 v25, v230, v231
    v_add_f32 v26, v232, v233
    v_mfma_f32_16x16x32_bf16 v[240:243], v[132:135], v[212:215], v[240:243]
    v_add_f32 v27, v234, v235
    v_max3_u32 v29, v228, v229, v230
    v_add_f32 v24, v24, v25
    s_waitcnt vmcnt(2)
    v_max3_u32 v31, v31, v216, v217
    v_max3_u32 v31, v31, v218, v219
    v_mfma_f32_16x16x32_bf16 v[236:239], v[136:139], v[216:219], v[236:239]
    v_add_f32 v26, v26, v27
    v_max3_u32 v29, v29, v231, v232
    v_add_f32 v24, v24, v26
    v_mfma_f32_16x16x32_bf16 v[240:243], v[140:143], v[216:219], v[240:243]
    v_max3_u32 v29, v29, v233, v234
    v_mov_b32 v25, v24
    v_max_u32 v29, v29, v235
    s_waitcnt vmcnt(1)
    v_max3_u32 v31, v31, v220, v221
    v_max3_u32 v31, v31, v222, v223
    v_mfma_f32_16x16x32_bf16 v[236:239], v[144:147], v[220:223], v[236:239]
    v_permlane16_swap_b32 v24, v25
    v_add_f32 v24, v24, v25
    v_mov_b32 v25, v24
    v_mfma_f32_16x16x32_bf16 v[240:243], v[148:151], v[220:223], v[240:243]
    s_nop 0
    v_permlane32_swap_b32 v24, v25
    v_add_f32 v24, v24, v25
    s_nop 1
    v_mov_b32_dpp v26, v24 row_ror:8 row_mask:0xf bank_mask:0xf
    s_waitcnt vmcnt(0)
    v_max3_u32 v31, v31, v224, v225
    v_max3_u32 v31, v31, v226, v227
    v_mfma_f32_16x16x32_bf16 v[236:239], v[152:155], v[224:227], v[236:239]
    v_mul_f32 v27, 0x3b000000, v24
    v_mul_f32 v26, 0x3b000000, v26
    v_fma_f32 v26, -v27, v27, v26
    v_mfma_f32_16x16x32_bf16 v[240:243], v[156:159], v[224:227], v[240:243]
    v_max_f32 v26, 0, v26
    v_add_f32 v26, 0x3727c5ac, v26
    v_rsq_f32 v28, v26
    v_max_u32 v31, v31, v29
    v_cmp_eq_u32 vcc, -1, v31
    s_cbranch_vccz Lcd_36
    s_sub_u32 s52, s52, 1
    s_cbranch_scc0 Lcg_35
    s_mov_b32 s3, 0
Lcd_36:
    s_nop 1
    v_add_f32_dpp v236, v240, v236 row_ror:8 row_mask:0xf bank_mask:0xf
    v_add_f32_dpp v237, v241, v237 row_ror:8 row_mask:0xf bank_mask:0xf
    v_add_f32_dpp v238, v242, v238 row_ror:8 row_mask:0xf bank_mask:0xf
    v_add_f32_dpp v239, v243, v239 row_ror:8 row_mask:0xf bank_mask:0xf
    v_fma_f32 v236, -v27, v188, v236
    v_fma_f32 v237, -v27, v189, v237
    v_fma_f32 v238, -v27, v190, v238
    v_fma_f32 v239, -v27, v191, v239
    v_mul_f32 v236, v236, v28
    v_mul_f32 v237, v237, v28
    v_mul_f32 v238, v238, v28
    v_mul_f32 v239, v239, v28
    v_add_f32 v236, v236, v192
    v_add_f32 v237, v237, v193
    v_add_f32 v238, v238, v194
    v_add_f32 v239, v239, v195
    s_mov_b32 s57, 0x42200000
    s_mov_b32 s58, 0x3fb8aa3b
    v_min_f32 v244, s57, v236
    v_min_f32 v245, s57, v237
    v_min_f32 v246, s57, v238
    v_min_f32 v247, s57, v239
    v_mul_f32 v244, s58, v244
    v_mul_f32 v245, s58, v245
    v_mul_f32 v246, s58, v246
    v_mul_f32 v247, s58, v247
    v_exp_f32 v244, v244
    v_exp_f32 v245, v245
    v_exp_f32 v246, v246
    v_exp_f32 v247, v247
    v_add_f32 v248, 2.0, v244
    v_add_f32 v249, 2.0, v245
    v_add_f32 v250, 2.0, v246
    v_add_f32 v251, 2.0, v247
    v_mul_f32 v244, v244, v248
    v_mul_f32 v245, v245, v249
    v_mul_f32 v246, v246, v250
    v_mul_f32 v247, v247, v251
    v_add_f32 v248, 2.0, v244
    v_add_f32 v249, 2.0, v245
    v_add_f32 v250, 2.0, v246
    v_add_f32 v251, 2.0, v247
    v_rcp_f32 v248, v248
    v_rcp_f32 v249, v249
    v_rcp_f32 v250, v250
    v_rcp_f32 v251, v251
    v_mul_f32 v244, v244, v236
    v_mul_f32 v245, v245, v237
    v_mul_f32 v246, v246, v238
    v_mul_f32 v247, v247, v239
    v_mul_f32 v236, v244, v248
    v_mul_f32 v237, v245, v249
    v_mul_f32 v238, v246, v250
    v_mul_f32 v239, v247, v251
    s_add_u32 s59, s54, 62464
    v_cvt_pk_bf16_f32 v24, v236, v237
    v_cvt_pk_bf16_f32 v25, v238, v239
    v_min_u32 v24, -2, v24
    v_min_u32 v25, -2, v25
    s_mov_b64 exec, s[64:65]
    s_cmp_eq_u32 s51, 0
    s_cbranch_scc1 Lpub_37
    buffer_store_dwordx2 v[24:25], v13, s[28:31], s59 offen
    s_branch Lpub_38
Lpub_37:
    buffer_store_dwordx2 v[24:25], v13, s[28:31], s59 offen sc1
Lpub_38:
    s_mov_b64 exec, -1
L_P6:
    s_add_u32 s76, s54, 62464
    s_waitcnt vmcnt(0)
    s_mov_b32 s52, s3
Lcg_39:
    buffer_load_dwordx4 v[196:199], v9, s[28:31], s76 offen offset:0 sc1
    buffer_load_dwordx4 v[200:203], v9, s[28:31], s76 offen offset:1024 sc1
    buffer_load_dwordx4 v[204:207], v9, s[28:31], s76 offen offset:2048 sc1
    buffer_load_dwordx4 v[208:211], v9, s[28:31], s76 offen offset:3072 sc1
    s_waitcnt vmcnt(3)
    v_max3_u32 v31, v196, v197, v198
    v_max_u32 v31, v31, v199
    v_mfma_f32_16x16x32_bf16 v[228:231], v[160:163], v[196:199], 0
    v_mfma_f32_16x16x32_bf16 v[232:235], v[164:167], v[196:199], 0
    s_waitcnt vmcnt(2)
    v_max3_u32 v31, v31, v200, v201
    v_max3_u32 v31, v31, v202, v203
    v_mfma_f32_16x16x32_bf16 v[228:231], v[168:171], v[200:203], v[228:231]
    v_mfma_f32_16x16x32_bf16 v[232:235], v[172:175], v[200:203], v[232:235]
    s_waitcnt vmcnt(1)
    v_max3_u32 v31, v31, v204, v205
    v_max3_u32 v31, v31, v206, v207
    v_mfma_f32_16x16x32_bf16 v[228:231], v[176:179], v[204:207], v[228:231]
    v_mfma_f32_16x16x32_bf16 v[232:235], v[180:183], v[204:207], v[232:235]
    s_waitcnt vmcnt(0)
    v_max3_u32 v30, v208, v209, v210
    v_max_u32 v30, v30, v211
    v_mfma_f32_16x16x32_bf16 v[228:231], v[184:187], v[208:211], v[228:231]
    v_cmp_eq_u32 vcc, -1, v31
    s_nop 0
    s_mov_b64 s[72:73], vcc
    v_cmp_eq_u32 vcc, -1, v30
    s_nop 0
    s_and_b64 vcc, vcc, s[64:65]
    s_or_b64 vcc, vcc, s[72:73]
    s_cbranch_vccz Lcd_40
    s_sub_u32 s52, s52, 1
    s_cbranch_scc0 Lcg_39
    s_mov_b32 s3, 0
Lcd_40:
    v_add_f32_dpp v228, v232, v228 row_ror:8 row_mask:0xf bank_mask:0xf
    v_add_f32_dpp v229, v233, v229 row_ror:8 row_mask:0xf bank_mask:0xf
    v_add_f32_dpp v230, v234, v230 row_ror:8 row_mask:0xf bank_mask:0xf
    v_add_f32_dpp v231, v235, v231 row_ror:8 row_mask:0xf bank_mask:0xf
    v_min_u32 v228, -2, v228
    v_min_u32 v229, -2, v229
    v_min_u32 v230, -2, v230
    v_min_u32 v231, -2, v231
    s_mov_b64 exec, s[64:65]
    buffer_store_dwordx4 v[228:231], v14, s[28:31], s56 offen sc1
    s_mov_b64 exec, -1
    s_waitcnt vmcnt(0)
L_G1:
    s_waitcnt lgkmcnt(0)
    s_barrier
    s_cmp_eq_u32 s48, 1
    s_cbranch_scc1 L_w1path
    s_cmp_eq_u32 s53, 1
    s_cbranch_scc1 L_fin
    s_mov_b32 s53, 1
    s_mov_b32 s54, s63
    s_add_u32 s55, s55, 262144
    s_add_u32 s56, s56, 131072
    s_branch L_barA
L_w1path:
    s_lshl_b32 s57, s50, 12
    s_add_u32 s57, s57, s56
    ds_read_b128 v[228:231], v23
    s_waitcnt vmcnt(0)
    s_mov_b32 s52, s3
Lpoll_41:
    buffer_load_dwordx4 v[196:199], v9, s[28:31], s57 offen offset:0 sc1
    buffer_load_dwordx4 v[200:203], v9, s[28:31], s57 offen offset:1024 sc1
    buffer_load_dwordx4 v[204:207], v9, s[28:31], s57 offen offset:2048 sc1
    buffer_load_dwordx4 v[208:211], v9, s[28:31], s57 offen offset:3072 sc1
    s_waitcnt vmcnt(0)
    v_max3_u32 v31, v196, v197, v198
    v_max3_u32 v31, v31, v199, v200
    v_max3_u32 v31, v31, v201, v202
    v_max3_u32 v31, v31, v203, v204
    v_max3_u32 v31, v31, v205, v206
    v_max3_u32 v31, v31, v207, v208
    v_max3_u32 v31, v31, v209, v210
    v_max_u32 v31, v31, v211
    v_cmp_eq_u32 vcc, -1, v31
    s_cbranch_vccz Lpd_42
    s_sub_u32 s52, s52, 1
    s_cbranch_scc0 Lpoll_41
    s_mov_b32 s3, 0
Lpd_42:
    v_pk_add_f32 v[232:233], v[196:197], v[204:205]
    v_pk_add_f32 v[234:235], v[198:199], v[206:207]
    v_pk_add_f32 v[236:237], v[200:201], v[208:209]
    v_pk_add_f32 v[238:239], v[202:203], v[210:211]
    v_pk_add_f32 v[232:233], v[232:233], v[236:237]
    v_pk_add_f32 v[234:235], v[234:235], v[238:239]
    v_mov_b32 v236, v232
    v_mov_b32 v237, v233
    v_mov_b32 v238, v234
    v_mov_b32 v239, v235
    v_permlane32_swap_b32 v232, v236
    v_permlane32_swap_b32 v233, v237
    v_permlane32_swap_b32 v234, v238
    v_permlane32_swap_b32 v235, v239
    s_waitcnt lgkmcnt(0)
    v_add_f32 v232, v232, v236
    v_add_f32 v233, v233, v237
    v_add_f32 v234, v234, v238
    v_add_f32 v235, v235, v239
    v_add_f32 v232, v232, v228
    v_add_f32 v233, v233, v229
    v_add_f32 v234, v234, v230
    v_add_f32 v235, v235, v231
    s_cmp_eq_u32 s53, 1
    s_cbranch_scc1 L_final
    s_mov_b32 s53, 1
    s_mov_b32 s54, s63
    s_add_u32 s55, s55, 262144
    s_add_u32 s56, s56, 131072
    s_add_u32 s79, s54, 16384
    s_add_u32 s59, s54, 0
    s_add_u32 s60, s54, 57344
    v_cvt_pk_bf16_f32 v24, v232, v233
    v_cvt_pk_bf16_f32 v25, v234, v235
    v_min_u32 v24, -2, v24
    v_min_u32 v25, -2, v25
    s_mov_b64 exec, s[66:67]
    s_cmp_eq_u32 s51, 0
    s_cbranch_scc1 Lpub_43
    buffer_store_dwordx2 v[24:25], v6, s[28:31], s59 offen
    s_branch Lpub_44
Lpub_43:
    buffer_store_dwordx2 v[24:25], v6, s[28:31], s59 offen sc1
Lpub_44:
    s_mov_b64 exec, -1
    v_lshlrev_b32 v232, 16, v24
    v_and_b32 v233, 0xffff0000, v24
    v_lshlrev_b32 v234, 16, v25
    v_and_b32 v235, 0xffff0000, v25
    v_add_f32 v26, v232, v233
    v_add_f32 v28, v234, v235
    v_mul_f32 v27, v232, v232
    v_add_f32 v26, v26, v28
    v_fmac_f32 v27, v233, v233
    v_fmac_f32 v27, v234, v234
    v_fmac_f32 v27, v235, v235
    v_add_f32_dpp v26, v26, v26 row_ror:8 row_mask:0xf bank_mask:0xf
    s_nop 0
    v_add_f32_dpp v27, v27, v27 row_ror:8 row_mask:0xf bank_mask:0xf
    v_cndmask_b32 v26, v26, v27, s[70:71]
    v_mov_b32 v28, v26
    s_nop 1
    v_permlane16_swap_b32 v26, v28
    v_add_f32 v26, v26, v28
    v_min_u32 v26, -2, v26
    s_mov_b64 exec, 0xffff
    s_cmp_eq_u32 s51, 0
    s_cbranch_scc1 Lpub_45
    buffer_store_dword v26, v7, s[28:31], s60 offen
    s_branch Lpub_46
Lpub_45:
    buffer_store_dword v26, v7, s[28:31], s60 offen sc1
Lpub_46:
    s_mov_b64 exec, -1
    ds_write_b128 v23, v[232:235]
    s_branch L_P1
L_final:
    v_cvt_pk_bf16_f32 v24, v232, v233
    v_cvt_pk_bf16_f32 v25, v234, v235
    v_min_u32 v24, -2, v24
    v_min_u32 v25, -2, v25
    v_and_b32 v26, 7, v1
    v_cmp_eq_u32 vcc, s49, v26
    s_nop 0
    s_and_b64 exec, vcc, s[66:67]
    buffer_store_dwordx2 v[24:25], v5, s[44:47], 0 offen
    s_mov_b64 exec, -1
L_fin:
    s_endpgm
L_end:
    s_endpgm
.section .rodata,"a"
.p2align 6
.amdhsa_kernel interleave_layers__sliding_block_cached__dense_activation_mish__decode_kernel
  .amdhsa_next_free_vgpr 256
  .amdhsa_next_free_sgpr 102
  .amdhsa_accum_offset 256
  .amdhsa_group_segment_fixed_size 0
  .amdhsa_kernarg_size 96
  .amdhsa_user_sgpr_count 2
  .amdhsa_user_sgpr_kernarg_segment_ptr 1
  .amdhsa_system_sgpr_workgroup_id_x 1
.end_amdhsa_kernel
```
